```python
import torch

def _softmax(x, axis=-1):
    return torch.softmax(x, dim=axis)
def _gelu(x):
    return torch.nn.functional.gelu(x, approximate="tanh")
def _silu(x):
    return torch.nn.functional.silu(x)
def _sigmoid(x):
    return torch.sigmoid(x)
def _layernorm(x, axis=-1, eps=1e-5):
    m = x.mean(dim=axis, keepdim=True)
    v = x.var(dim=axis, keepdim=True, unbiased=False)
    return (x - m) / torch.sqrt(v + eps)
def _scatter_add(tgt, idx, src, axis=0):
    return tgt.clone().index_add_(axis, idx, src)
def _segment_sum(src, seg, n):
    out = torch.zeros((n,) + src.shape[1:], dtype=src.dtype)
    return out.index_add_(0, seg, src)
def _pad(x, pw):
    flat = tuple(v for pair in reversed(pw) for v in pair)
    return torch.nn.functional.pad(x, flat)

kernel_name = 'concat_heads__mha_block_cached__mha_block_cached__decode'

def setup_inputs():

    _w = (lambda a: (lambda t: t.to(torch.bfloat16) if t.is_floating_point() else t)(torch.as_tensor(a)))
    def _A_setup():
        B, Sq, D = 4, 1, 512
        H, Sk, Dh = 32, 4096, 128
        return {
            "x": _w((lambda *s: torch.randn(*s, dtype=torch.bfloat16) * 0.8)(B, Sq, D)),
            "k_cache": _w((lambda *s: torch.randn(*s, dtype=torch.bfloat16) * 1.6)(B, H, Sk, Dh)),
            "v_cache": _w((lambda *s: torch.randn(*s, dtype=torch.bfloat16) * 0.2)(B, H, Sk, Dh)),
            "wq": _w((lambda *s: torch.randn(*s, dtype=torch.bfloat16) * 1.6)(D, H * Dh) * (D ** -0.5)),
            "wo": _w((lambda *s: torch.randn(*s, dtype=torch.bfloat16) * 0.2)(H * Dh, D) * ((H * Dh) ** -0.5)),
        }
    _A_in = _A_setup()

    def _B_setup():
        B, Sq, D = 4, 1, 512
        H, Sk, Dh = 32, 4096, 128
        return {
            "x": _w((lambda *s: torch.randn(*s, dtype=torch.bfloat16) * 0.8)(B, Sq, D)),
            "k_cache": _w((lambda *s: torch.randn(*s, dtype=torch.bfloat16) * 1.6)(B, H, Sk, Dh)),
            "v_cache": _w((lambda *s: torch.randn(*s, dtype=torch.bfloat16) * 0.2)(B, H, Sk, Dh)),
            "wq": _w((lambda *s: torch.randn(*s, dtype=torch.bfloat16) * 1.6)(D, H * Dh) * (D ** -0.5)),
            "wo": _w((lambda *s: torch.randn(*s, dtype=torch.bfloat16) * 0.2)(H * Dh, D) * ((H * Dh) ** -0.5)),
        }
    _B_in = _B_setup()

    return {
        "A_x": _A_in["x"],
        "A_k_cache": _A_in["k_cache"],
        "A_v_cache": _A_in["v_cache"],
        "A_wq": _A_in["wq"],
        "A_wo": _A_in["wo"],
        "B_x": _B_in["x"],
        "B_k_cache": _B_in["k_cache"],
        "B_v_cache": _B_in["v_cache"],
        "B_wq": _B_in["wq"],
        "B_wo": _B_in["wo"],
    }

def reference(A_x, A_k_cache, A_v_cache, A_wq, A_wo, B_x, B_k_cache, B_v_cache, B_wq, B_wo):
    def _A_ref(x, k_cache, v_cache, wq, wo):
        B, Sq, D = x.shape
        H, Dh = 32, 128
        q = (lambda x, *d: x.permute(*d))((x @ wq).reshape(B, Sq, H, Dh), 0, 2, 1, 3)
        scores = torch.einsum("bhqd,bhkd->bhqk", q, k_cache) * (Dh ** -0.5)
        p = _softmax(scores, axis=-1)
        o = torch.einsum("bhqk,bhkd->bhqd", p, v_cache)
        return (lambda x, *d: x.permute(*d))(o, 0, 2, 1, 3).reshape(B, Sq, H * Dh) @ wo

    def _B_ref(x, k_cache, v_cache, wq, wo):
        B, Sq, D = x.shape
        H, Dh = 32, 128
        q = (lambda x, *d: x.permute(*d))((x @ wq).reshape(B, Sq, H, Dh), 0, 2, 1, 3)
        scores = torch.einsum("bhqd,bhkd->bhqk", q, k_cache) * (Dh ** -0.5)
        p = _softmax(scores, axis=-1)
        o = torch.einsum("bhqk,bhkd->bhqd", p, v_cache)
        return (lambda x, *d: x.permute(*d))(o, 0, 2, 1, 3).reshape(B, Sq, H * Dh) @ wo

    a = _A_ref(A_x, A_k_cache, A_v_cache, A_wq, A_wo)
    b = _B_ref(B_x, B_k_cache, B_v_cache, B_wq, B_wo)
    return torch.concatenate([a, b], axis=-1)
```

```asm
; @launch grid=(256,1,1) block=(256,1,1) lds=6144
.amdgcn_target "amdgcn-amd-amdhsa--gfx950"
.text
.globl concat_heads__mha_block_cached__mha_block_cached__decode_kernel
.p2align 8
.type concat_heads__mha_block_cached__mha_block_cached__decode_kernel,@function
concat_heads__mha_block_cached__mha_block_cached__decode_kernel:
    s_cmp_ge_u32 s2, 256
    s_cbranch_scc1 L_end
    s_load_dwordx16 s[40:55], s[0:1], 0
    s_load_dwordx8 s[56:63], s[0:1], 64
    s_load_dwordx2 s[64:65], s[0:1], 96
    v_lshrrev_b32 v20, 6, v0
    v_and_b32 v1, 63, v0
    v_readfirstlane_b32 s66, v20
    s_lshr_b32 s67, s2, 7
    s_bfe_u32 s68, s2, 0x20005
    s_and_b32 s69, s2, 31
    s_lshr_b32 s84, s2, 5
    v_lshrrev_b32 v20, 4, v1
    v_and_b32 v21, 15, v1
    v_bfe_u32 v22, v1, 2, 2
    v_and_b32 v23, 3, v1
    v_lshlrev_b32 v3, 4, v1
    v_mov_b32 v13, 0
    v_mov_b32 v15, 0
    s_and_b32 s74, s2, 127
    s_lshl_b32 s86, s74, 20
    s_mov_b32 s26, 0x1000
    s_mov_b32 s27, 0x20000
    s_mov_b32 s18, 0x400000
    s_mov_b32 s19, 0x20000
    s_mov_b32 s10, 0x100000
    s_mov_b32 s11, 0x20000
    s_mov_b32 s14, 0x100000
    s_mov_b32 s15, 0x20000
    s_mov_b32 s22, 0x20000
    s_mov_b32 s23, 0x20000
    s_mov_b32 s34, 0x2000
    s_mov_b32 s35, 0x20000
    s_mov_b32 s30, 0x100000
    s_mov_b32 s31, 0x20000
    v_lshlrev_b32 v2, 8, v22
    v_lshl_add_u32 v2, v20, 6, v2
    v_lshl_add_u32 v2, v23, 4, v2
    v_lshlrev_b32 v56, 4, v21
    v_lshl_add_u32 v4, v20, 13, v56
    v_lshl_add_u32 v5, v20, 10, v56
    s_mul_i32 s94, s68, 8
    v_add_u32 v6, s94, v21
    v_and_b32 v6, 31, v6
    v_lshl_add_u32 v6, v6, 2, v20
    v_lshlrev_b32 v6, 1, v6
    v_xor_b32 v7, 0x80, v6
    s_lshl_b32 s74, s66, 20
    s_lshl_b32 s75, s69, 8
    s_add_u32 s74, s74, s75
    v_add_u32 v4, s74, v4
    s_lshl_b32 s74, s66, 8
    v_add_u32 v5, s74, v5
    s_lshl_b32 s75, s68, 10
    s_lshl_b32 s74, s66, 8
    s_add_u32 s73, s74, s75
    s_lshl_b32 s72, s94, 15
    s_mul_i32 s70, s66, 1024
    s_mov_b32 s71, s70
    s_mul_i32 s87, s84, 4352
    s_add_u32 s87, s87, 0x80000
    s_cmp_eq_u32 s67, 0
    s_waitcnt lgkmcnt(0)
    s_cselect_b32 s24, s40, s50
    s_cselect_b32 s25, s41, s51
    s_cselect_b32 s16, s46, s56
    s_cselect_b32 s17, s47, s57
    s_cselect_b32 s8, s42, s52
    s_cselect_b32 s9, s43, s53
    s_cselect_b32 s12, s44, s54
    s_cselect_b32 s13, s45, s55
    s_cselect_b32 s20, s48, s58
    s_cselect_b32 s21, s49, s59
    buffer_load_ushort v18, v6, s[24:27], s73 offen
    buffer_load_ushort v19, v7, s[24:27], s73 offen
    s_add_u32 s8, s8, s86
    s_addc_u32 s9, s9, 0
    buffer_load_dwordx4 v[92:95], v4, s[16:19], s72 offen
    s_add_u32 s72, s72, 32768
    buffer_load_dwordx4 v[96:99], v4, s[16:19], s72 offen
    s_add_u32 s72, s72, 32768
    buffer_load_dwordx4 v[100:103], v4, s[16:19], s72 offen
    s_add_u32 s72, s72, 32768
    buffer_load_dwordx4 v[104:107], v4, s[16:19], s72 offen
    s_add_u32 s72, s72, 32768
    buffer_load_dwordx4 v[108:111], v4, s[16:19], s72 offen
    s_add_u32 s72, s72, 32768
    buffer_load_dwordx4 v[112:115], v4, s[16:19], s72 offen
    s_add_u32 s72, s72, 32768
    buffer_load_dwordx4 v[116:119], v4, s[16:19], s72 offen
    s_add_u32 s72, s72, 32768
    buffer_load_dwordx4 v[120:123], v4, s[16:19], s72 offen
    s_add_u32 s72, s72, 32768
    s_and_b32 s72, s72, 0xfffff
    buffer_load_dwordx4 v[124:127], v4, s[16:19], s72 offen
    s_add_u32 s72, s72, 32768
    s_add_u32 s12, s12, s86
    s_addc_u32 s13, s13, 0
    s_lshl_b32 s74, s69, 17
    s_add_u32 s20, s20, s74
    s_addc_u32 s21, s21, 0
    s_mov_b32 s32, s60
    s_mov_b32 s33, s61
    s_mov_b32 s28, s64
    s_mov_b32 s29, s65
    s_mov_b32 s83, 0x3e0293ee
    v_cmp_eq_u32 s[76:77], 1, v23
    v_cmp_eq_u32 s[78:79], 2, v23
    v_cmp_eq_u32 s[80:81], 3, v23
    v_and_b32 v56, 1, v21
    v_mov_b32 v57, 0xffff
    v_lshlrev_b32 v56, 4, v56
    v_lshlrev_b32 v57, v56, v57
    v_lshrrev_b32 v58, 1, v21
    v_cmp_eq_u32 vcc, 0, v58
    s_nop 1
    v_cndmask_b32 v24, 0, v57, vcc
    v_cmp_eq_u32 vcc, 1, v58
    s_nop 1
    v_cndmask_b32 v25, 0, v57, vcc
    v_cmp_eq_u32 vcc, 2, v58
    s_nop 1
    v_cndmask_b32 v26, 0, v57, vcc
    v_cmp_eq_u32 vcc, 3, v58
    s_nop 1
    v_cndmask_b32 v27, 0, v57, vcc
    s_mul_i32 s95, s68, 8
    v_add_u32 v60, 0, v21
    v_add_u32 v61, s95, v60
    v_subrev_u32 v62, 32, v61
    v_min_u32 v61, v61, v62
    v_cmp_gt_u32 vcc, 32, v60
    s_nop 1
    v_cndmask_b32 v60, v60, v61, vcc
    v_lshl_add_u32 v60, v60, 2, v20
    v_lshlrev_b32 v10, 2, v60
    v_add_u32 v60, 16, v21
    v_add_u32 v61, s95, v60
    v_subrev_u32 v62, 32, v61
    v_min_u32 v61, v61, v62
    v_cmp_gt_u32 vcc, 32, v60
    s_nop 1
    v_cndmask_b32 v60, v60, v61, vcc
    v_lshl_add_u32 v60, v60, 2, v20
    v_lshlrev_b32 v11, 2, v60
    s_lshl_b32 s95, s95, 12
    s_lshl_b32 s74, s66, 9
    v_lshlrev_b32 v9, 5, v21
    v_lshl_add_u32 v9, v20, 4, v9
    v_add_u32 v9, s74, v9
    s_lshl_b32 s74, s66, 8
    v_lshl_add_u32 v12, v20, 2, v23
    v_lshlrev_b32 v12, 4, v12
    v_add_u32 v12, s74, v12
    s_lshl_b32 s74, s66, 2
    v_mov_b32 v17, s74
    s_lshl_b32 s74, s84, 16
    s_lshl_b32 s75, s66, 14
    s_add_u32 s74, s74, s75
    s_lshl_b32 s75, s69, 6
    s_add_u32 s74, s74, s75
    v_lshlrev_b32 v8, 11, v58
    v_lshl_add_u32 v8, v56, 1, v8
    v_lshl_add_u32 v8, v20, 4, v8
    v_add_u32 v8, s74, v8
    s_lshl_b32 s74, s2, 11
    v_add_u32 v16, s74, v3
    s_lshl_b32 s74, s68, 10
    s_lshl_b32 s75, s67, 9
    s_add_u32 s74, s74, s75
    s_lshl_b32 s75, s69, 4
    s_add_u32 s74, s74, s75
    v_lshl_add_u32 v88, v23, 2, v20
    v_add_u32 v88, s74, v88
    v_lshlrev_b32 v88, 1, v88
    s_waitcnt vmcnt(9)
    v_lshl_or_b32 v18, v18, 16, v18
    v_lshl_or_b32 v19, v19, 16, v19
    s_nop 1
    v_and_b32_dpp v28, v18, v24 row_newbcast:0 row_mask:0xf bank_mask:0xf
    v_and_b32_dpp v29, v18, v25 row_newbcast:0 row_mask:0xf bank_mask:0xf
    v_and_b32_dpp v30, v18, v26 row_newbcast:0 row_mask:0xf bank_mask:0xf
    v_and_b32_dpp v31, v18, v27 row_newbcast:0 row_mask:0xf bank_mask:0xf
    v_and_b32_dpp v32, v18, v24 row_newbcast:1 row_mask:0xf bank_mask:0xf
    v_and_b32_dpp v33, v18, v25 row_newbcast:1 row_mask:0xf bank_mask:0xf
    v_and_b32_dpp v34, v18, v26 row_newbcast:1 row_mask:0xf bank_mask:0xf
    v_and_b32_dpp v35, v18, v27 row_newbcast:1 row_mask:0xf bank_mask:0xf
    s_waitcnt vmcnt(8)
    v_mfma_f32_16x16x32_bf16 v[36:39], v[28:31], v[92:95], 0
    v_and_b32_dpp v28, v18, v24 row_newbcast:2 row_mask:0xf bank_mask:0xf
    v_and_b32_dpp v29, v18, v25 row_newbcast:2 row_mask:0xf bank_mask:0xf
    v_and_b32_dpp v30, v18, v26 row_newbcast:2 row_mask:0xf bank_mask:0xf
    v_and_b32_dpp v31, v18, v27 row_newbcast:2 row_mask:0xf bank_mask:0xf
    s_waitcnt vmcnt(7)
    v_mfma_f32_16x16x32_bf16 v[36:39], v[32:35], v[96:99], v[36:39]
    v_and_b32_dpp v32, v18, v24 row_newbcast:3 row_mask:0xf bank_mask:0xf
    v_and_b32_dpp v33, v18, v25 row_newbcast:3 row_mask:0xf bank_mask:0xf
    v_and_b32_dpp v34, v18, v26 row_newbcast:3 row_mask:0xf bank_mask:0xf
    v_and_b32_dpp v35, v18, v27 row_newbcast:3 row_mask:0xf bank_mask:0xf
    s_waitcnt vmcnt(6)
    v_mfma_f32_16x16x32_bf16 v[36:39], v[28:31], v[100:103], v[36:39]
    buffer_load_dwordx4 a[0:3], v2, s[8:11], s70 offen offset:0 nt
    s_add_u32 s70, s70, 4096
    v_and_b32_dpp v28, v18, v24 row_newbcast:4 row_mask:0xf bank_mask:0xf
    v_and_b32_dpp v29, v18, v25 row_newbcast:4 row_mask:0xf bank_mask:0xf
    v_and_b32_dpp v30, v18, v26 row_newbcast:4 row_mask:0xf bank_mask:0xf
    v_and_b32_dpp v31, v18, v27 row_newbcast:4 row_mask:0xf bank_mask:0xf
    s_waitcnt vmcnt(6)
    v_mfma_f32_16x16x32_bf16 v[36:39], v[32:35], v[104:107], v[36:39]
    buffer_load_dwordx4 a[4:7], v2, s[8:11], s70 offen offset:0 nt
    s_add_u32 s70, s70, 4096
    buffer_load_dwordx4 v[128:131], v4, s[16:19], s72 offen
    s_add_u32 s72, s72, 32768
    v_and_b32_dpp v32, v18, v24 row_newbcast:5 row_mask:0xf bank_mask:0xf
    v_and_b32_dpp v33, v18, v25 row_newbcast:5 row_mask:0xf bank_mask:0xf
    v_and_b32_dpp v34, v18, v26 row_newbcast:5 row_mask:0xf bank_mask:0xf
    v_and_b32_dpp v35, v18, v27 row_newbcast:5 row_mask:0xf bank_mask:0xf
    s_waitcnt vmcnt(7)
    v_mfma_f32_16x16x32_bf16 v[36:39], v[28:31], v[108:111], v[36:39]
    buffer_load_dwordx4 a[8:11], v2, s[8:11], s70 offen offset:0 nt
    s_add_u32 s70, s70, 4096
    v_and_b32_dpp v28, v18, v24 row_newbcast:6 row_mask:0xf bank_mask:0xf
    v_and_b32_dpp v29, v18, v25 row_newbcast:6 row_mask:0xf bank_mask:0xf
    v_and_b32_dpp v30, v18, v26 row_newbcast:6 row_mask:0xf bank_mask:0xf
    v_and_b32_dpp v31, v18, v27 row_newbcast:6 row_mask:0xf bank_mask:0xf
    s_waitcnt vmcnt(7)
    v_mfma_f32_16x16x32_bf16 v[36:39], v[32:35], v[112:115], v[36:39]
    buffer_load_dwordx4 a[12:15], v2, s[8:11], s70 offen offset:0 nt
    s_add_u32 s70, s70, 4096
    buffer_load_dwordx4 v[132:135], v4, s[16:19], s72 offen
    s_add_u32 s72, s72, 32768
    v_and_b32_dpp v32, v18, v24 row_newbcast:7 row_mask:0xf bank_mask:0xf
    v_and_b32_dpp v33, v18, v25 row_newbcast:7 row_mask:0xf bank_mask:0xf
    v_and_b32_dpp v34, v18, v26 row_newbcast:7 row_mask:0xf bank_mask:0xf
    v_and_b32_dpp v35, v18, v27 row_newbcast:7 row_mask:0xf bank_mask:0xf
    s_waitcnt vmcnt(8)
    v_mfma_f32_16x16x32_bf16 v[36:39], v[28:31], v[116:119], v[36:39]
    buffer_load_dwordx4 a[16:19], v2, s[8:11], s70 offen offset:0 nt
    s_add_u32 s70, s70, 4096
    v_and_b32_dpp v28, v18, v24 row_newbcast:8 row_mask:0xf bank_mask:0xf
    v_and_b32_dpp v29, v18, v25 row_newbcast:8 row_mask:0xf bank_mask:0xf
    v_and_b32_dpp v30, v18, v26 row_newbcast:8 row_mask:0xf bank_mask:0xf
    v_and_b32_dpp v31, v18, v27 row_newbcast:8 row_mask:0xf bank_mask:0xf
    s_waitcnt vmcnt(8)
    v_mfma_f32_16x16x32_bf16 v[36:39], v[32:35], v[120:123], v[36:39]
    buffer_load_dwordx4 a[20:23], v2, s[8:11], s70 offen offset:0 nt
    s_add_u32 s70, s70, 4096
    buffer_load_dwordx4 v[136:139], v4, s[16:19], s72 offen
    s_add_u32 s72, s72, 32768
    v_and_b32_dpp v32, v18, v24 row_newbcast:9 row_mask:0xf bank_mask:0xf
    v_and_b32_dpp v33, v18, v25 row_newbcast:9 row_mask:0xf bank_mask:0xf
    v_and_b32_dpp v34, v18, v26 row_newbcast:9 row_mask:0xf bank_mask:0xf
    v_and_b32_dpp v35, v18, v27 row_newbcast:9 row_mask:0xf bank_mask:0xf
    s_waitcnt vmcnt(9)
    v_mfma_f32_16x16x32_bf16 v[36:39], v[28:31], v[124:127], v[36:39]
    v_and_b32_dpp v28, v18, v24 row_newbcast:10 row_mask:0xf bank_mask:0xf
    v_and_b32_dpp v29, v18, v25 row_newbcast:10 row_mask:0xf bank_mask:0xf
    v_and_b32_dpp v30, v18, v26 row_newbcast:10 row_mask:0xf bank_mask:0xf
    v_and_b32_dpp v31, v18, v27 row_newbcast:10 row_mask:0xf bank_mask:0xf
    s_waitcnt vmcnt(8)
    buffer_load_dwordx4 a[24:27], v2, s[8:11], s70 offen offset:0 nt
    s_add_u32 s70, s70, 4096
    s_waitcnt vmcnt(8)
    buffer_load_dwordx4 a[28:31], v2, s[8:11], s70 offen offset:0 nt
    s_add_u32 s70, s70, 4096
    buffer_load_dwordx4 v[140:143], v4, s[16:19], s72 offen
    s_add_u32 s72, s72, 32768
    s_waitcnt vmcnt(9)
    v_mfma_f32_16x16x32_bf16 v[36:39], v[32:35], v[128:131], v[36:39]
    v_and_b32_dpp v32, v18, v24 row_newbcast:11 row_mask:0xf bank_mask:0xf
    v_and_b32_dpp v33, v18, v25 row_newbcast:11 row_mask:0xf bank_mask:0xf
    v_and_b32_dpp v34, v18, v26 row_newbcast:11 row_mask:0xf bank_mask:0xf
    v_and_b32_dpp v35, v18, v27 row_newbcast:11 row_mask:0xf bank_mask:0xf
    s_waitcnt vmcnt(8)
    buffer_load_dwordx4 a[32:35], v2, s[8:11], s70 offen offset:0 nt
    s_add_u32 s70, s70, 4096
    s_waitcnt vmcnt(8)
    buffer_load_dwordx4 a[36:39], v2, s[8:11], s70 offen offset:0 nt
    s_add_u32 s70, s70, 4096
    buffer_load_dwordx4 v[144:147], v4, s[16:19], s72 offen
    s_add_u32 s72, s72, 32768
    s_waitcnt vmcnt(9)
    v_mfma_f32_16x16x32_bf16 v[36:39], v[28:31], v[132:135], v[36:39]
    v_and_b32_dpp v28, v18, v24 row_newbcast:12 row_mask:0xf bank_mask:0xf
    v_and_b32_dpp v29, v18, v25 row_newbcast:12 row_mask:0xf bank_mask:0xf
    v_and_b32_dpp v30, v18, v26 row_newbcast:12 row_mask:0xf bank_mask:0xf
    v_and_b32_dpp v31, v18, v27 row_newbcast:12 row_mask:0xf bank_mask:0xf
    s_waitcnt vmcnt(8)
    buffer_load_dwordx4 a[40:43], v2, s[8:11], s70 offen offset:0 nt
    s_add_u32 s70, s70, 4096
    s_waitcnt vmcnt(8)
    buffer_load_dwordx4 a[44:47], v2, s[8:11], s70 offen offset:0 nt
    s_add_u32 s70, s70, 4096
    buffer_load_dwordx4 v[148:151], v4, s[16:19], s72 offen
    s_add_u32 s72, s72, 32768
    s_waitcnt vmcnt(9)
    v_mfma_f32_16x16x32_bf16 v[36:39], v[32:35], v[136:139], v[36:39]
    v_and_b32_dpp v32, v18, v24 row_newbcast:13 row_mask:0xf bank_mask:0xf
    v_and_b32_dpp v33, v18, v25 row_newbcast:13 row_mask:0xf bank_mask:0xf
    v_and_b32_dpp v34, v18, v26 row_newbcast:13 row_mask:0xf bank_mask:0xf
    v_and_b32_dpp v35, v18, v27 row_newbcast:13 row_mask:0xf bank_mask:0xf
    s_waitcnt vmcnt(8)
    buffer_load_dwordx4 a[48:51], v2, s[8:11], s70 offen offset:0 nt
    s_add_u32 s70, s70, 4096
    s_waitcnt vmcnt(8)
    buffer_load_dwordx4 a[52:55], v2, s[8:11], s70 offen offset:0 nt
    s_add_u32 s70, s70, 4096
    buffer_load_dwordx4 v[152:155], v4, s[16:19], s72 offen
    s_add_u32 s72, s72, 32768
    s_and_b32 s72, s72, 0xfffff
    s_waitcnt vmcnt(9)
    v_mfma_f32_16x16x32_bf16 v[36:39], v[28:31], v[140:143], v[36:39]
    v_and_b32_dpp v28, v18, v24 row_newbcast:14 row_mask:0xf bank_mask:0xf
    v_and_b32_dpp v29, v18, v25 row_newbcast:14 row_mask:0xf bank_mask:0xf
    v_and_b32_dpp v30, v18, v26 row_newbcast:14 row_mask:0xf bank_mask:0xf
    v_and_b32_dpp v31, v18, v27 row_newbcast:14 row_mask:0xf bank_mask:0xf
    s_waitcnt vmcnt(8)
    buffer_load_dwordx4 a[56:59], v2, s[8:11], s70 offen offset:0 nt
    s_add_u32 s70, s70, 4096
    s_waitcnt vmcnt(8)
    buffer_load_dwordx4 a[60:63], v2, s[8:11], s70 offen offset:0 nt
    s_add_u32 s70, s70, 4096
    buffer_load_dwordx4 v[92:95], v4, s[16:19], s72 offen
    s_add_u32 s72, s72, 32768
    s_waitcnt vmcnt(9)
    v_mfma_f32_16x16x32_bf16 v[36:39], v[32:35], v[144:147], v[36:39]
    v_and_b32_dpp v32, v18, v24 row_newbcast:15 row_mask:0xf bank_mask:0xf
    v_and_b32_dpp v33, v18, v25 row_newbcast:15 row_mask:0xf bank_mask:0xf
    v_and_b32_dpp v34, v18, v26 row_newbcast:15 row_mask:0xf bank_mask:0xf
    v_and_b32_dpp v35, v18, v27 row_newbcast:15 row_mask:0xf bank_mask:0xf
    s_waitcnt vmcnt(8)
    buffer_load_dwordx4 a[64:67], v2, s[8:11], s70 offen offset:0 nt
    s_add_u32 s70, s70, 4096
    s_waitcnt vmcnt(8)
    buffer_load_dwordx4 a[68:71], v2, s[8:11], s70 offen offset:0 nt
    s_add_u32 s70, s70, 4096
    buffer_load_dwordx4 v[96:99], v4, s[16:19], s72 offen
    s_add_u32 s72, s72, 32768
    s_waitcnt vmcnt(9)
    v_mfma_f32_16x16x32_bf16 v[36:39], v[28:31], v[148:151], v[36:39]
    v_and_b32_dpp v28, v19, v24 row_newbcast:0 row_mask:0xf bank_mask:0xf
    v_and_b32_dpp v29, v19, v25 row_newbcast:0 row_mask:0xf bank_mask:0xf
    v_and_b32_dpp v30, v19, v26 row_newbcast:0 row_mask:0xf bank_mask:0xf
    v_and_b32_dpp v31, v19, v27 row_newbcast:0 row_mask:0xf bank_mask:0xf
    s_waitcnt vmcnt(8)
    buffer_load_dwordx4 a[72:75], v2, s[8:11], s70 offen offset:0 nt
    s_add_u32 s70, s70, 4096
    s_waitcnt vmcnt(8)
    buffer_load_dwordx4 a[76:79], v2, s[8:11], s70 offen offset:0 nt
    s_add_u32 s70, s70, 4096
    buffer_load_dwordx4 v[100:103], v4, s[16:19], s72 offen
    s_add_u32 s72, s72, 32768
    s_waitcnt vmcnt(9)
    v_mfma_f32_16x16x32_bf16 v[36:39], v[32:35], v[152:155], v[36:39]
    v_and_b32_dpp v32, v19, v24 row_newbcast:1 row_mask:0xf bank_mask:0xf
    v_and_b32_dpp v33, v19, v25 row_newbcast:1 row_mask:0xf bank_mask:0xf
    v_and_b32_dpp v34, v19, v26 row_newbcast:1 row_mask:0xf bank_mask:0xf
    v_and_b32_dpp v35, v19, v27 row_newbcast:1 row_mask:0xf bank_mask:0xf
    s_waitcnt vmcnt(8)
    buffer_load_dwordx4 a[80:83], v2, s[8:11], s70 offen offset:0 nt
    s_add_u32 s70, s70, 4096
    s_waitcnt vmcnt(8)
    buffer_load_dwordx4 a[84:87], v2, s[8:11], s70 offen offset:0 nt
    s_add_u32 s70, s70, 4096
    buffer_load_dwordx4 v[104:107], v4, s[16:19], s72 offen
    s_add_u32 s72, s72, 32768
    s_waitcnt vmcnt(9)
    v_mfma_f32_16x16x32_bf16 v[36:39], v[28:31], v[92:95], v[36:39]
    v_and_b32_dpp v28, v19, v24 row_newbcast:2 row_mask:0xf bank_mask:0xf
    v_and_b32_dpp v29, v19, v25 row_newbcast:2 row_mask:0xf bank_mask:0xf
    v_and_b32_dpp v30, v19, v26 row_newbcast:2 row_mask:0xf bank_mask:0xf
    v_and_b32_dpp v31, v19, v27 row_newbcast:2 row_mask:0xf bank_mask:0xf
    s_waitcnt vmcnt(8)
    buffer_load_dwordx4 a[88:91], v2, s[8:11], s70 offen offset:0 nt
    s_add_u32 s70, s70, 4096
    s_waitcnt vmcnt(8)
    buffer_load_dwordx4 a[92:95], v2, s[8:11], s70 offen offset:0 nt
    s_add_u32 s70, s70, 4096
    buffer_load_dwordx4 v[108:111], v4, s[16:19], s72 offen
    s_add_u32 s72, s72, 32768
    s_waitcnt vmcnt(9)
    v_mfma_f32_16x16x32_bf16 v[36:39], v[32:35], v[96:99], v[36:39]
    v_and_b32_dpp v32, v19, v24 row_newbcast:3 row_mask:0xf bank_mask:0xf
    v_and_b32_dpp v33, v19, v25 row_newbcast:3 row_mask:0xf bank_mask:0xf
    v_and_b32_dpp v34, v19, v26 row_newbcast:3 row_mask:0xf bank_mask:0xf
    v_and_b32_dpp v35, v19, v27 row_newbcast:3 row_mask:0xf bank_mask:0xf
    s_waitcnt vmcnt(8)
    buffer_load_dwordx4 a[96:99], v2, s[8:11], s70 offen offset:0 nt
    s_add_u32 s70, s70, 4096
    s_waitcnt vmcnt(8)
    buffer_load_dwordx4 a[100:103], v2, s[8:11], s70 offen offset:0 nt
    s_add_u32 s70, s70, 4096
    buffer_load_dwordx4 v[112:115], v4, s[16:19], s72 offen
    s_add_u32 s72, s72, 32768
    s_waitcnt vmcnt(9)
    v_mfma_f32_16x16x32_bf16 v[36:39], v[28:31], v[100:103], v[36:39]
    v_and_b32_dpp v28, v19, v24 row_newbcast:4 row_mask:0xf bank_mask:0xf
    v_and_b32_dpp v29, v19, v25 row_newbcast:4 row_mask:0xf bank_mask:0xf
    v_and_b32_dpp v30, v19, v26 row_newbcast:4 row_mask:0xf bank_mask:0xf
    v_and_b32_dpp v31, v19, v27 row_newbcast:4 row_mask:0xf bank_mask:0xf
    s_waitcnt vmcnt(8)
    buffer_load_dwordx4 a[104:107], v2, s[8:11], s70 offen offset:0 nt
    s_add_u32 s70, s70, 4096
    s_waitcnt vmcnt(8)
    buffer_load_dwordx4 a[108:111], v2, s[8:11], s70 offen offset:0 nt
    s_add_u32 s70, s70, 4096
    buffer_load_dwordx4 v[116:119], v4, s[16:19], s72 offen
    s_add_u32 s72, s72, 32768
    s_waitcnt vmcnt(9)
    v_mfma_f32_16x16x32_bf16 v[36:39], v[32:35], v[104:107], v[36:39]
    v_and_b32_dpp v32, v19, v24 row_newbcast:5 row_mask:0xf bank_mask:0xf
    v_and_b32_dpp v33, v19, v25 row_newbcast:5 row_mask:0xf bank_mask:0xf
    v_and_b32_dpp v34, v19, v26 row_newbcast:5 row_mask:0xf bank_mask:0xf
    v_and_b32_dpp v35, v19, v27 row_newbcast:5 row_mask:0xf bank_mask:0xf
    s_waitcnt vmcnt(8)
    buffer_load_dwordx4 a[112:115], v2, s[8:11], s70 offen offset:0 nt
    s_add_u32 s70, s70, 4096
    s_waitcnt vmcnt(8)
    buffer_load_dwordx4 a[116:119], v2, s[8:11], s70 offen offset:0 nt
    s_add_u32 s70, s70, 4096
    buffer_load_dwordx4 v[120:123], v4, s[16:19], s72 offen
    s_add_u32 s72, s72, 32768
    s_and_b32 s72, s72, 0xfffff
    s_waitcnt vmcnt(9)
    v_mfma_f32_16x16x32_bf16 v[36:39], v[28:31], v[108:111], v[36:39]
    v_and_b32_dpp v28, v19, v24 row_newbcast:6 row_mask:0xf bank_mask:0xf
    v_and_b32_dpp v29, v19, v25 row_newbcast:6 row_mask:0xf bank_mask:0xf
    v_and_b32_dpp v30, v19, v26 row_newbcast:6 row_mask:0xf bank_mask:0xf
    v_and_b32_dpp v31, v19, v27 row_newbcast:6 row_mask:0xf bank_mask:0xf
    s_waitcnt vmcnt(8)
    buffer_load_dwordx4 a[120:123], v2, s[8:11], s70 offen offset:0 nt
    s_add_u32 s70, s70, 4096
    s_waitcnt vmcnt(8)
    buffer_load_dwordx4 a[124:127], v2, s[8:11], s70 offen offset:0 nt
    s_add_u32 s70, s70, 4096
    buffer_load_dwordx4 v[124:127], v4, s[16:19], s72 offen
    s_add_u32 s72, s72, 32768
    s_waitcnt vmcnt(9)
    v_mfma_f32_16x16x32_bf16 v[36:39], v[32:35], v[112:115], v[36:39]
    v_and_b32_dpp v32, v19, v24 row_newbcast:7 row_mask:0xf bank_mask:0xf
    v_and_b32_dpp v33, v19, v25 row_newbcast:7 row_mask:0xf bank_mask:0xf
    v_and_b32_dpp v34, v19, v26 row_newbcast:7 row_mask:0xf bank_mask:0xf
    v_and_b32_dpp v35, v19, v27 row_newbcast:7 row_mask:0xf bank_mask:0xf
    s_waitcnt vmcnt(8)
    buffer_load_dwordx4 a[128:131], v2, s[8:11], s70 offen offset:0 nt
    s_add_u32 s70, s70, 4096
    s_waitcnt vmcnt(8)
    buffer_load_dwordx4 a[132:135], v2, s[8:11], s70 offen offset:0 nt
    s_add_u32 s70, s70, 4096
    buffer_load_dwordx4 v[128:131], v4, s[16:19], s72 offen
    s_add_u32 s72, s72, 32768
    s_waitcnt vmcnt(9)
    v_mfma_f32_16x16x32_bf16 v[36:39], v[28:31], v[116:119], v[36:39]
    v_and_b32_dpp v28, v19, v24 row_newbcast:8 row_mask:0xf bank_mask:0xf
    v_and_b32_dpp v29, v19, v25 row_newbcast:8 row_mask:0xf bank_mask:0xf
    v_and_b32_dpp v30, v19, v26 row_newbcast:8 row_mask:0xf bank_mask:0xf
    v_and_b32_dpp v31, v19, v27 row_newbcast:8 row_mask:0xf bank_mask:0xf
    s_waitcnt vmcnt(8)
    buffer_load_dwordx4 a[136:139], v2, s[8:11], s70 offen offset:0 nt
    s_add_u32 s70, s70, 4096
    s_waitcnt vmcnt(8)
    buffer_load_dwordx4 a[140:143], v2, s[8:11], s70 offen offset:0 nt
    s_add_u32 s70, s70, 4096
    buffer_load_dwordx4 v[132:135], v4, s[16:19], s72 offen
    s_add_u32 s72, s72, 32768
    s_waitcnt vmcnt(9)
    v_mfma_f32_16x16x32_bf16 v[36:39], v[32:35], v[120:123], v[36:39]
    v_and_b32_dpp v32, v19, v24 row_newbcast:9 row_mask:0xf bank_mask:0xf
    v_and_b32_dpp v33, v19, v25 row_newbcast:9 row_mask:0xf bank_mask:0xf
    v_and_b32_dpp v34, v19, v26 row_newbcast:9 row_mask:0xf bank_mask:0xf
    v_and_b32_dpp v35, v19, v27 row_newbcast:9 row_mask:0xf bank_mask:0xf
    s_waitcnt vmcnt(8)
    buffer_load_dwordx4 a[144:147], v2, s[8:11], s70 offen offset:0 nt
    s_add_u32 s70, s70, 4096
    s_waitcnt vmcnt(8)
    buffer_load_dwordx4 a[148:151], v2, s[8:11], s70 offen offset:0 nt
    s_add_u32 s70, s70, 4096
    buffer_load_dwordx4 v[136:139], v4, s[16:19], s72 offen
    s_add_u32 s72, s72, 32768
    s_waitcnt vmcnt(9)
    v_mfma_f32_16x16x32_bf16 v[36:39], v[28:31], v[124:127], v[36:39]
    v_and_b32_dpp v28, v19, v24 row_newbcast:10 row_mask:0xf bank_mask:0xf
    v_and_b32_dpp v29, v19, v25 row_newbcast:10 row_mask:0xf bank_mask:0xf
    v_and_b32_dpp v30, v19, v26 row_newbcast:10 row_mask:0xf bank_mask:0xf
    v_and_b32_dpp v31, v19, v27 row_newbcast:10 row_mask:0xf bank_mask:0xf
    s_waitcnt vmcnt(8)
    buffer_load_dwordx4 a[152:155], v2, s[8:11], s70 offen offset:0 nt
    s_add_u32 s70, s70, 4096
    s_waitcnt vmcnt(8)
    buffer_load_dwordx4 a[156:159], v2, s[8:11], s70 offen offset:0 nt
    s_add_u32 s70, s70, 4096
    buffer_load_dwordx4 v[140:143], v4, s[16:19], s72 offen
    s_add_u32 s72, s72, 32768
    s_waitcnt vmcnt(9)
    v_mfma_f32_16x16x32_bf16 v[36:39], v[32:35], v[128:131], v[36:39]
    v_and_b32_dpp v32, v19, v24 row_newbcast:11 row_mask:0xf bank_mask:0xf
    v_and_b32_dpp v33, v19, v25 row_newbcast:11 row_mask:0xf bank_mask:0xf
    v_and_b32_dpp v34, v19, v26 row_newbcast:11 row_mask:0xf bank_mask:0xf
    v_and_b32_dpp v35, v19, v27 row_newbcast:11 row_mask:0xf bank_mask:0xf
    s_waitcnt vmcnt(8)
    buffer_load_dwordx4 a[160:163], v2, s[8:11], s70 offen offset:0 nt
    s_add_u32 s70, s70, 4096
    s_waitcnt vmcnt(8)
    buffer_load_dwordx4 a[164:167], v2, s[8:11], s70 offen offset:0 nt
    s_add_u32 s70, s70, 4096
    buffer_load_dwordx4 v[144:147], v4, s[16:19], s72 offen
    s_add_u32 s72, s72, 32768
    s_waitcnt vmcnt(9)
    v_mfma_f32_16x16x32_bf16 v[36:39], v[28:31], v[132:135], v[36:39]
    v_and_b32_dpp v28, v19, v24 row_newbcast:12 row_mask:0xf bank_mask:0xf
    v_and_b32_dpp v29, v19, v25 row_newbcast:12 row_mask:0xf bank_mask:0xf
    v_and_b32_dpp v30, v19, v26 row_newbcast:12 row_mask:0xf bank_mask:0xf
    v_and_b32_dpp v31, v19, v27 row_newbcast:12 row_mask:0xf bank_mask:0xf
    s_waitcnt vmcnt(8)
    buffer_load_dwordx4 a[168:171], v2, s[8:11], s70 offen offset:0 nt
    s_add_u32 s70, s70, 4096
    s_waitcnt vmcnt(8)
    buffer_load_dwordx4 a[172:175], v2, s[8:11], s70 offen offset:0 nt
    s_add_u32 s70, s70, 4096
    buffer_load_dwordx4 v[148:151], v4, s[16:19], s72 offen
    s_add_u32 s72, s72, 32768
    s_waitcnt vmcnt(9)
    v_mfma_f32_16x16x32_bf16 v[36:39], v[32:35], v[136:139], v[36:39]
    v_and_b32_dpp v32, v19, v24 row_newbcast:13 row_mask:0xf bank_mask:0xf
    v_and_b32_dpp v33, v19, v25 row_newbcast:13 row_mask:0xf bank_mask:0xf
    v_and_b32_dpp v34, v19, v26 row_newbcast:13 row_mask:0xf bank_mask:0xf
    v_and_b32_dpp v35, v19, v27 row_newbcast:13 row_mask:0xf bank_mask:0xf
    s_waitcnt vmcnt(8)
    buffer_load_dwordx4 a[176:179], v2, s[8:11], s70 offen offset:0 nt
    s_add_u32 s70, s70, 4096
    s_waitcnt vmcnt(8)
    buffer_load_dwordx4 a[180:183], v2, s[8:11], s70 offen offset:0 nt
    s_add_u32 s70, s70, 4096
    buffer_load_dwordx4 v[152:155], v4, s[16:19], s72 offen
    s_waitcnt vmcnt(9)
    v_mfma_f32_16x16x32_bf16 v[36:39], v[28:31], v[140:143], v[36:39]
    v_and_b32_dpp v28, v19, v24 row_newbcast:14 row_mask:0xf bank_mask:0xf
    v_and_b32_dpp v29, v19, v25 row_newbcast:14 row_mask:0xf bank_mask:0xf
    v_and_b32_dpp v30, v19, v26 row_newbcast:14 row_mask:0xf bank_mask:0xf
    v_and_b32_dpp v31, v19, v27 row_newbcast:14 row_mask:0xf bank_mask:0xf
    s_waitcnt vmcnt(8)
    buffer_load_dwordx4 a[184:187], v2, s[8:11], s70 offen offset:0 nt
    s_add_u32 s70, s70, 4096
    s_waitcnt vmcnt(8)
    buffer_load_dwordx4 a[188:191], v2, s[8:11], s70 offen offset:0 nt
    s_add_u32 s70, s70, 4096
    s_waitcnt vmcnt(8)
    v_mfma_f32_16x16x32_bf16 v[36:39], v[32:35], v[144:147], v[36:39]
    v_and_b32_dpp v32, v19, v24 row_newbcast:15 row_mask:0xf bank_mask:0xf
    v_and_b32_dpp v33, v19, v25 row_newbcast:15 row_mask:0xf bank_mask:0xf
    v_and_b32_dpp v34, v19, v26 row_newbcast:15 row_mask:0xf bank_mask:0xf
    v_and_b32_dpp v35, v19, v27 row_newbcast:15 row_mask:0xf bank_mask:0xf
    s_waitcnt vmcnt(7)
    buffer_load_dwordx4 a[192:195], v2, s[8:11], s70 offen offset:0 nt
    s_add_u32 s70, s70, 4096
    s_waitcnt vmcnt(7)
    buffer_load_dwordx4 a[196:199], v2, s[8:11], s70 offen offset:0 nt
    s_add_u32 s70, s70, 4096
    s_waitcnt vmcnt(7)
    v_mfma_f32_16x16x32_bf16 v[36:39], v[28:31], v[148:151], v[36:39]
    s_waitcnt vmcnt(6)
    buffer_load_dwordx4 a[200:203], v2, s[8:11], s70 offen offset:0 nt
    s_add_u32 s70, s70, 4096
    s_waitcnt vmcnt(6)
    buffer_load_dwordx4 a[204:207], v2, s[8:11], s70 offen offset:0 nt
    s_add_u32 s70, s70, 4096
    s_waitcnt vmcnt(6)
    s_nop 0
    v_mfma_f32_16x16x32_bf16 v[36:39], v[32:35], v[152:155], v[36:39]
    v_lshlrev_b32 v20, 3, v1
    s_lshl_b32 s74, s66, 8
    v_lshl_add_u32 v21, v1, 2, s74
    s_nop 4
    s_mov_b32 exec_hi, 0
    ds_write_b128 v9, v[36:39] offset:0
    s_mov_b32 exec_hi, -1
    s_waitcnt lgkmcnt(0)
    s_barrier
    ds_read_b64 v[56:57], v20 offset:0
    ds_read_b64 v[58:59], v20 offset:512
    ds_read_b64 v[60:61], v20 offset:1024
    ds_read_b64 v[62:63], v20 offset:1536
    s_waitcnt lgkmcnt(0)
    v_add_f32 v56, v56, v60
    v_add_f32 v57, v57, v61
    v_add_f32 v58, v58, v62
    v_add_f32 v59, v59, v63
    v_add_f32 v56, v56, v58
    v_add_f32 v57, v57, v59
    v_cvt_pk_bf16_f32 v56, v56, v57
    ds_write_b32 v21, v56 offset:2048
    ds_read_b128 v[60:63], v12 offset:2048
    s_waitcnt vmcnt(5)
    s_waitcnt lgkmcnt(0)
    v_cmp_eq_u32 vcc, 0, v22
    s_nop 1
    v_cndmask_b32 v40, 0, v60, vcc
    v_cndmask_b32 v41, 0, v61, vcc
    v_cndmask_b32 v42, 0, v62, vcc
    v_cndmask_b32 v43, 0, v63, vcc
    v_cmp_eq_u32 vcc, 1, v22
    s_nop 1
    v_cndmask_b32 v44, 0, v60, vcc
    v_cndmask_b32 v45, 0, v61, vcc
    v_cndmask_b32 v46, 0, v62, vcc
    v_cndmask_b32 v47, 0, v63, vcc
    v_cmp_eq_u32 vcc, 2, v22
    s_nop 1
    v_cndmask_b32 v48, 0, v60, vcc
    v_cndmask_b32 v49, 0, v61, vcc
    v_cndmask_b32 v50, 0, v62, vcc
    v_cndmask_b32 v51, 0, v63, vcc
    v_cmp_eq_u32 vcc, 3, v22
    s_nop 1
    v_cndmask_b32 v52, 0, v60, vcc
    v_cndmask_b32 v53, 0, v61, vcc
    v_cndmask_b32 v54, 0, v62, vcc
    v_cndmask_b32 v55, 0, v63, vcc
    s_nop 0
    v_mfma_f32_16x16x32_bf16 v[56:59], a[0:3], v[40:43], 0
    v_mfma_f32_16x16x32_bf16 v[56:59], a[4:7], v[44:47], v[56:59]
    v_mfma_f32_16x16x32_bf16 v[56:59], a[8:11], v[48:51], v[56:59]
    v_mfma_f32_16x16x32_bf16 v[56:59], a[12:15], v[52:55], v[56:59]
    v_mfma_f32_16x16x32_bf16 v[60:63], a[16:19], v[40:43], 0
    v_mfma_f32_16x16x32_bf16 v[60:63], a[20:23], v[44:47], v[60:63]
    v_mfma_f32_16x16x32_bf16 v[60:63], a[24:27], v[48:51], v[60:63]
    v_mfma_f32_16x16x32_bf16 v[60:63], a[28:31], v[52:55], v[60:63]
    v_mfma_f32_16x16x32_bf16 v[64:67], a[32:35], v[40:43], 0
    s_waitcnt vmcnt(4)
    buffer_load_dwordx4 a[208:211], v2, s[8:11], s70 offen offset:0 nt
    s_add_u32 s70, s70, 4096
    v_mfma_f32_16x16x32_bf16 v[64:67], a[36:39], v[44:47], v[64:67]
    v_mfma_f32_16x16x32_bf16 v[64:67], a[40:43], v[48:51], v[64:67]
    v_mfma_f32_16x16x32_bf16 v[64:67], a[44:47], v[52:55], v[64:67]
    v_mfma_f32_16x16x32_bf16 v[68:71], a[48:51], v[40:43], 0
    v_mfma_f32_16x16x32_bf16 v[68:71], a[52:55], v[44:47], v[68:71]
    v_mfma_f32_16x16x32_bf16 v[68:71], a[56:59], v[48:51], v[68:71]
    v_mfma_f32_16x16x32_bf16 v[68:71], a[60:63], v[52:55], v[68:71]
    s_nop 4
    v_add_f32_dpp v20, v57, v56 quad_perm:[1,1,1,1] row_mask:0xf bank_mask:0xf
    v_add_f32_dpp v21, v60, v61 quad_perm:[0,0,0,0] row_mask:0xf bank_mask:0xf
    v_add_f32_dpp v22, v64, v66 quad_perm:[0,0,0,0] row_mask:0xf bank_mask:0xf
    v_add_f32_dpp v23, v68, v71 quad_perm:[0,0,0,0] row_mask:0xf bank_mask:0xf
    v_add_f32_dpp v20, v58, v20 quad_perm:[2,2,2,2] row_mask:0xf bank_mask:0xf
    v_add_f32_dpp v21, v62, v21 quad_perm:[2,2,2,2] row_mask:0xf bank_mask:0xf
    v_add_f32_dpp v22, v65, v22 quad_perm:[1,1,1,1] row_mask:0xf bank_mask:0xf
    v_add_f32_dpp v23, v69, v23 quad_perm:[1,1,1,1] row_mask:0xf bank_mask:0xf
    v_add_f32_dpp v72, v59, v20 quad_perm:[3,3,3,3] row_mask:0xf bank_mask:0xf
    v_add_f32_dpp v21, v63, v21 quad_perm:[3,3,3,3] row_mask:0xf bank_mask:0xf
    v_add_f32_dpp v22, v67, v22 quad_perm:[3,3,3,3] row_mask:0xf bank_mask:0xf
    v_add_f32_dpp v23, v70, v23 quad_perm:[2,2,2,2] row_mask:0xf bank_mask:0xf
    v_cndmask_b32 v72, v72, v21, s[76:77]
    v_cndmask_b32 v72, v72, v22, s[78:79]
    v_cndmask_b32 v72, v72, v23, s[80:81]
    v_mfma_f32_16x16x32_bf16 v[56:59], a[64:67], v[40:43], 0
    v_mfma_f32_16x16x32_bf16 v[56:59], a[68:71], v[44:47], v[56:59]
    v_mfma_f32_16x16x32_bf16 v[56:59], a[72:75], v[48:51], v[56:59]
    s_waitcnt vmcnt(4)
    buffer_load_dwordx4 a[212:215], v2, s[8:11], s70 offen offset:0 nt
    s_add_u32 s70, s70, 4096
    v_mfma_f32_16x16x32_bf16 v[56:59], a[76:79], v[52:55], v[56:59]
    v_mfma_f32_16x16x32_bf16 v[60:63], a[80:83], v[40:43], 0
    v_mfma_f32_16x16x32_bf16 v[60:63], a[84:87], v[44:47], v[60:63]
    v_mfma_f32_16x16x32_bf16 v[60:63], a[88:91], v[48:51], v[60:63]
    v_mfma_f32_16x16x32_bf16 v[60:63], a[92:95], v[52:55], v[60:63]
    v_mfma_f32_16x16x32_bf16 v[64:67], a[96:99], v[40:43], 0
    v_mfma_f32_16x16x32_bf16 v[64:67], a[100:103], v[44:47], v[64:67]
    v_mfma_f32_16x16x32_bf16 v[64:67], a[104:107], v[48:51], v[64:67]
    v_mfma_f32_16x16x32_bf16 v[64:67], a[108:111], v[52:55], v[64:67]
    v_mfma_f32_16x16x32_bf16 v[68:71], a[112:115], v[40:43], 0
    s_waitcnt vmcnt(4)
    buffer_load_dwordx4 a[216:219], v2, s[8:11], s70 offen offset:0 nt
    s_add_u32 s70, s70, 4096
    v_mfma_f32_16x16x32_bf16 v[68:71], a[116:119], v[44:47], v[68:71]
    v_mfma_f32_16x16x32_bf16 v[68:71], a[120:123], v[48:51], v[68:71]
    v_mfma_f32_16x16x32_bf16 v[68:71], a[124:127], v[52:55], v[68:71]
    s_nop 4
    v_add_f32_dpp v20, v57, v56 quad_perm:[1,1,1,1] row_mask:0xf bank_mask:0xf
    v_add_f32_dpp v21, v60, v61 quad_perm:[0,0,0,0] row_mask:0xf bank_mask:0xf
    v_add_f32_dpp v22, v64, v66 quad_perm:[0,0,0,0] row_mask:0xf bank_mask:0xf
    v_add_f32_dpp v23, v68, v71 quad_perm:[0,0,0,0] row_mask:0xf bank_mask:0xf
    v_add_f32_dpp v20, v58, v20 quad_perm:[2,2,2,2] row_mask:0xf bank_mask:0xf
    v_add_f32_dpp v21, v62, v21 quad_perm:[2,2,2,2] row_mask:0xf bank_mask:0xf
    v_add_f32_dpp v22, v65, v22 quad_perm:[1,1,1,1] row_mask:0xf bank_mask:0xf
    v_add_f32_dpp v23, v69, v23 quad_perm:[1,1,1,1] row_mask:0xf bank_mask:0xf
    v_add_f32_dpp v73, v59, v20 quad_perm:[3,3,3,3] row_mask:0xf bank_mask:0xf
    v_add_f32_dpp v21, v63, v21 quad_perm:[3,3,3,3] row_mask:0xf bank_mask:0xf
    v_add_f32_dpp v22, v67, v22 quad_perm:[3,3,3,3] row_mask:0xf bank_mask:0xf
    v_add_f32_dpp v23, v70, v23 quad_perm:[2,2,2,2] row_mask:0xf bank_mask:0xf
    v_cndmask_b32 v73, v73, v21, s[76:77]
    v_cndmask_b32 v73, v73, v22, s[78:79]
    v_cndmask_b32 v73, v73, v23, s[80:81]
    v_mfma_f32_16x16x32_bf16 v[56:59], a[128:131], v[40:43], 0
    v_mfma_f32_16x16x32_bf16 v[56:59], a[132:135], v[44:47], v[56:59]
    v_mfma_f32_16x16x32_bf16 v[56:59], a[136:139], v[48:51], v[56:59]
    v_mfma_f32_16x16x32_bf16 v[56:59], a[140:143], v[52:55], v[56:59]
    v_mfma_f32_16x16x32_bf16 v[60:63], a[144:147], v[40:43], 0
    v_mfma_f32_16x16x32_bf16 v[60:63], a[148:151], v[44:47], v[60:63]
    v_mfma_f32_16x16x32_bf16 v[60:63], a[152:155], v[48:51], v[60:63]
    s_waitcnt vmcnt(4)
    buffer_load_dwordx4 a[220:223], v2, s[8:11], s70 offen offset:0 nt
    s_add_u32 s70, s70, 4096
    v_mfma_f32_16x16x32_bf16 v[60:63], a[156:159], v[52:55], v[60:63]
    v_mfma_f32_16x16x32_bf16 v[64:67], a[160:163], v[40:43], 0
    v_mfma_f32_16x16x32_bf16 v[64:67], a[164:167], v[44:47], v[64:67]
    v_mfma_f32_16x16x32_bf16 v[64:67], a[168:171], v[48:51], v[64:67]
    v_mfma_f32_16x16x32_bf16 v[64:67], a[172:175], v[52:55], v[64:67]
    v_mfma_f32_16x16x32_bf16 v[68:71], a[176:179], v[40:43], 0
    v_mfma_f32_16x16x32_bf16 v[68:71], a[180:183], v[44:47], v[68:71]
    v_mfma_f32_16x16x32_bf16 v[68:71], a[184:187], v[48:51], v[68:71]
    v_mfma_f32_16x16x32_bf16 v[68:71], a[188:191], v[52:55], v[68:71]
    s_nop 4
    v_add_f32_dpp v20, v57, v56 quad_perm:[1,1,1,1] row_mask:0xf bank_mask:0xf
    v_add_f32_dpp v21, v60, v61 quad_perm:[0,0,0,0] row_mask:0xf bank_mask:0xf
    v_add_f32_dpp v22, v64, v66 quad_perm:[0,0,0,0] row_mask:0xf bank_mask:0xf
    v_add_f32_dpp v23, v68, v71 quad_perm:[0,0,0,0] row_mask:0xf bank_mask:0xf
    v_add_f32_dpp v20, v58, v20 quad_perm:[2,2,2,2] row_mask:0xf bank_mask:0xf
    v_add_f32_dpp v21, v62, v21 quad_perm:[2,2,2,2] row_mask:0xf bank_mask:0xf
    v_add_f32_dpp v22, v65, v22 quad_perm:[1,1,1,1] row_mask:0xf bank_mask:0xf
    v_add_f32_dpp v23, v69, v23 quad_perm:[1,1,1,1] row_mask:0xf bank_mask:0xf
    v_add_f32_dpp v74, v59, v20 quad_perm:[3,3,3,3] row_mask:0xf bank_mask:0xf
    v_add_f32_dpp v21, v63, v21 quad_perm:[3,3,3,3] row_mask:0xf bank_mask:0xf
    v_add_f32_dpp v22, v67, v22 quad_perm:[3,3,3,3] row_mask:0xf bank_mask:0xf
    v_add_f32_dpp v23, v70, v23 quad_perm:[2,2,2,2] row_mask:0xf bank_mask:0xf
    v_cndmask_b32 v74, v74, v21, s[76:77]
    v_cndmask_b32 v74, v74, v22, s[78:79]
    v_cndmask_b32 v74, v74, v23, s[80:81]
    v_mfma_f32_16x16x32_bf16 v[56:59], a[192:195], v[40:43], 0
    s_waitcnt vmcnt(4)
    buffer_load_dwordx4 a[224:227], v2, s[8:11], s70 offen offset:0 nt
    s_add_u32 s70, s70, 4096
    v_mfma_f32_16x16x32_bf16 v[56:59], a[196:199], v[44:47], v[56:59]
    v_mfma_f32_16x16x32_bf16 v[56:59], a[200:203], v[48:51], v[56:59]
    v_mfma_f32_16x16x32_bf16 v[56:59], a[204:207], v[52:55], v[56:59]
    s_waitcnt vmcnt(4)
    v_mfma_f32_16x16x32_bf16 v[60:63], a[208:211], v[40:43], 0
    buffer_load_dwordx4 a[228:231], v2, s[8:11], s70 offen offset:0 nt
    s_add_u32 s70, s70, 4096
    s_waitcnt vmcnt(4)
    v_mfma_f32_16x16x32_bf16 v[60:63], a[212:215], v[44:47], v[60:63]
    buffer_load_dwordx4 a[232:235], v2, s[8:11], s70 offen offset:0 nt
    s_add_u32 s70, s70, 4096
    s_waitcnt vmcnt(4)
    v_mfma_f32_16x16x32_bf16 v[60:63], a[216:219], v[48:51], v[60:63]
    buffer_load_dwordx4 a[236:239], v2, s[8:11], s70 offen offset:0 nt
    s_add_u32 s70, s70, 4096
    s_waitcnt vmcnt(4)
    v_mfma_f32_16x16x32_bf16 v[60:63], a[220:223], v[52:55], v[60:63]
    buffer_load_dwordx4 a[240:243], v2, s[8:11], s70 offen offset:0 nt
    s_add_u32 s70, s70, 4096
    s_waitcnt vmcnt(4)
    v_mfma_f32_16x16x32_bf16 v[64:67], a[224:227], v[40:43], 0
    buffer_load_dwordx4 a[244:247], v2, s[8:11], s70 offen offset:0 nt
    s_add_u32 s70, s70, 4096
    s_waitcnt vmcnt(4)
    v_mfma_f32_16x16x32_bf16 v[64:67], a[228:231], v[44:47], v[64:67]
    buffer_load_dwordx4 a[248:251], v2, s[8:11], s70 offen offset:0 nt
    s_add_u32 s70, s70, 4096
    s_waitcnt vmcnt(4)
    v_mfma_f32_16x16x32_bf16 v[64:67], a[232:235], v[48:51], v[64:67]
    buffer_load_dwordx4 a[252:255], v2, s[8:11], s70 offen offset:0 nt
    s_add_u32 s70, s70, 4096
    s_waitcnt vmcnt(4)
    v_mfma_f32_16x16x32_bf16 v[64:67], a[236:239], v[52:55], v[64:67]
    buffer_load_dwordx4 v[92:95], v2, s[8:11], s70 offen offset:0 nt
    s_add_u32 s70, s70, 4096
    s_waitcnt vmcnt(4)
    v_mfma_f32_16x16x32_bf16 v[68:71], a[240:243], v[40:43], 0
    buffer_load_dwordx4 v[96:99], v2, s[8:11], s70 offen offset:0 nt
    s_add_u32 s70, s70, 4096
    s_waitcnt vmcnt(4)
    v_mfma_f32_16x16x32_bf16 v[68:71], a[244:247], v[44:47], v[68:71]
    buffer_load_dwordx4 v[100:103], v2, s[8:11], s70 offen offset:0 nt
    s_add_u32 s70, s70, 4096
    s_waitcnt vmcnt(4)
    v_mfma_f32_16x16x32_bf16 v[68:71], a[248:251], v[48:51], v[68:71]
    buffer_load_dwordx4 v[104:107], v2, s[8:11], s70 offen offset:0 nt
    s_add_u32 s70, s70, 4096
    s_waitcnt vmcnt(4)
    v_mfma_f32_16x16x32_bf16 v[68:71], a[252:255], v[52:55], v[68:71]
    buffer_load_dwordx4 v[108:111], v2, s[8:11], s70 offen offset:0 nt
    s_add_u32 s70, s70, 4096
    s_nop 4
    v_add_f32_dpp v20, v57, v56 quad_perm:[1,1,1,1] row_mask:0xf bank_mask:0xf
    v_add_f32_dpp v21, v60, v61 quad_perm:[0,0,0,0] row_mask:0xf bank_mask:0xf
    v_add_f32_dpp v22, v64, v66 quad_perm:[0,0,0,0] row_mask:0xf bank_mask:0xf
    v_add_f32_dpp v23, v68, v71 quad_perm:[0,0,0,0] row_mask:0xf bank_mask:0xf
    v_add_f32_dpp v20, v58, v20 quad_perm:[2,2,2,2] row_mask:0xf bank_mask:0xf
    v_add_f32_dpp v21, v62, v21 quad_perm:[2,2,2,2] row_mask:0xf bank_mask:0xf
    v_add_f32_dpp v22, v65, v22 quad_perm:[1,1,1,1] row_mask:0xf bank_mask:0xf
    v_add_f32_dpp v23, v69, v23 quad_perm:[1,1,1,1] row_mask:0xf bank_mask:0xf
    v_add_f32_dpp v75, v59, v20 quad_perm:[3,3,3,3] row_mask:0xf bank_mask:0xf
    v_add_f32_dpp v21, v63, v21 quad_perm:[3,3,3,3] row_mask:0xf bank_mask:0xf
    v_add_f32_dpp v22, v67, v22 quad_perm:[3,3,3,3] row_mask:0xf bank_mask:0xf
    v_add_f32_dpp v23, v70, v23 quad_perm:[2,2,2,2] row_mask:0xf bank_mask:0xf
    v_cndmask_b32 v75, v75, v21, s[76:77]
    v_cndmask_b32 v75, v75, v22, s[78:79]
    v_cndmask_b32 v75, v75, v23, s[80:81]
    s_waitcnt vmcnt(4)
    v_mfma_f32_16x16x32_bf16 v[56:59], v[92:95], v[40:43], 0
    buffer_load_dwordx4 v[112:115], v2, s[8:11], s70 offen offset:0 nt
    s_add_u32 s70, s70, 4096
    s_waitcnt vmcnt(4)
    v_mfma_f32_16x16x32_bf16 v[56:59], v[96:99], v[44:47], v[56:59]
    buffer_load_dwordx4 v[116:119], v2, s[8:11], s70 offen offset:0 nt
    s_add_u32 s70, s70, 4096
    s_waitcnt vmcnt(4)
    v_mfma_f32_16x16x32_bf16 v[56:59], v[100:103], v[48:51], v[56:59]
    buffer_load_dwordx4 v[120:123], v2, s[8:11], s70 offen offset:0 nt
    s_add_u32 s70, s70, 4096
    s_waitcnt vmcnt(4)
    v_mfma_f32_16x16x32_bf16 v[56:59], v[104:107], v[52:55], v[56:59]
    buffer_load_dwordx4 v[124:127], v2, s[8:11], s70 offen offset:0 nt
    s_add_u32 s70, s70, 4096
    s_waitcnt vmcnt(4)
    v_mfma_f32_16x16x32_bf16 v[60:63], v[108:111], v[40:43], 0
    buffer_load_dwordx4 v[128:131], v2, s[8:11], s70 offen offset:0 nt
    s_add_u32 s70, s70, 4096
    s_waitcnt vmcnt(4)
    v_mfma_f32_16x16x32_bf16 v[60:63], v[112:115], v[44:47], v[60:63]
    buffer_load_dwordx4 v[132:135], v2, s[8:11], s70 offen offset:0 nt
    s_add_u32 s70, s70, 4096
    s_waitcnt vmcnt(4)
    v_mfma_f32_16x16x32_bf16 v[60:63], v[116:119], v[48:51], v[60:63]
    buffer_load_dwordx4 v[136:139], v2, s[8:11], s70 offen offset:0 nt
    s_add_u32 s70, s70, 4096
    s_waitcnt vmcnt(4)
    v_mfma_f32_16x16x32_bf16 v[60:63], v[120:123], v[52:55], v[60:63]
    buffer_load_dwordx4 v[140:143], v2, s[8:11], s70 offen offset:0 nt
    s_add_u32 s70, s70, 4096
    s_waitcnt vmcnt(4)
    v_mfma_f32_16x16x32_bf16 v[64:67], v[124:127], v[40:43], 0
    buffer_load_dwordx4 v[144:147], v2, s[8:11], s70 offen offset:0 nt
    s_add_u32 s70, s70, 4096
    s_waitcnt vmcnt(4)
    v_mfma_f32_16x16x32_bf16 v[64:67], v[128:131], v[44:47], v[64:67]
    buffer_load_dwordx4 v[148:151], v2, s[8:11], s70 offen offset:0 nt
    s_add_u32 s70, s70, 4096
    s_waitcnt vmcnt(4)
    v_mfma_f32_16x16x32_bf16 v[64:67], v[132:135], v[48:51], v[64:67]
    buffer_load_dwordx4 v[152:155], v2, s[8:11], s70 offen offset:0 nt
    s_add_u32 s70, s70, 4096
    s_waitcnt vmcnt(4)
    v_mfma_f32_16x16x32_bf16 v[64:67], v[136:139], v[52:55], v[64:67]
    buffer_load_dwordx4 v[92:95], v2, s[8:11], s70 offen offset:0 nt
    s_add_u32 s70, s70, 4096
    s_waitcnt vmcnt(4)
    v_mfma_f32_16x16x32_bf16 v[68:71], v[140:143], v[40:43], 0
    buffer_load_dwordx4 v[96:99], v2, s[8:11], s70 offen offset:0 nt
    s_add_u32 s70, s70, 4096
    s_waitcnt vmcnt(4)
    v_mfma_f32_16x16x32_bf16 v[68:71], v[144:147], v[44:47], v[68:71]
    buffer_load_dwordx4 v[100:103], v2, s[8:11], s70 offen offset:0 nt
    s_add_u32 s70, s70, 4096
    s_waitcnt vmcnt(4)
    v_mfma_f32_16x16x32_bf16 v[68:71], v[148:151], v[48:51], v[68:71]
    buffer_load_dwordx4 v[104:107], v2, s[8:11], s70 offen offset:0 nt
    s_add_u32 s70, s70, 4096
    s_waitcnt vmcnt(4)
    v_mfma_f32_16x16x32_bf16 v[68:71], v[152:155], v[52:55], v[68:71]
    buffer_load_dwordx4 v[108:111], v2, s[8:11], s70 offen offset:0 nt
    s_add_u32 s70, s70, 4096
    s_nop 4
    v_add_f32_dpp v20, v57, v56 quad_perm:[1,1,1,1] row_mask:0xf bank_mask:0xf
    v_add_f32_dpp v21, v60, v61 quad_perm:[0,0,0,0] row_mask:0xf bank_mask:0xf
    v_add_f32_dpp v22, v64, v66 quad_perm:[0,0,0,0] row_mask:0xf bank_mask:0xf
    v_add_f32_dpp v23, v68, v71 quad_perm:[0,0,0,0] row_mask:0xf bank_mask:0xf
    v_add_f32_dpp v20, v58, v20 quad_perm:[2,2,2,2] row_mask:0xf bank_mask:0xf
    v_add_f32_dpp v21, v62, v21 quad_perm:[2,2,2,2] row_mask:0xf bank_mask:0xf
    v_add_f32_dpp v22, v65, v22 quad_perm:[1,1,1,1] row_mask:0xf bank_mask:0xf
    v_add_f32_dpp v23, v69, v23 quad_perm:[1,1,1,1] row_mask:0xf bank_mask:0xf
    v_add_f32_dpp v76, v59, v20 quad_perm:[3,3,3,3] row_mask:0xf bank_mask:0xf
    v_add_f32_dpp v21, v63, v21 quad_perm:[3,3,3,3] row_mask:0xf bank_mask:0xf
    v_add_f32_dpp v22, v67, v22 quad_perm:[3,3,3,3] row_mask:0xf bank_mask:0xf
    v_add_f32_dpp v23, v70, v23 quad_perm:[2,2,2,2] row_mask:0xf bank_mask:0xf
    v_cndmask_b32 v76, v76, v21, s[76:77]
    v_cndmask_b32 v76, v76, v22, s[78:79]
    v_cndmask_b32 v76, v76, v23, s[80:81]
    s_waitcnt vmcnt(4)
    v_mfma_f32_16x16x32_bf16 v[56:59], v[92:95], v[40:43], 0
    buffer_load_dwordx4 v[112:115], v2, s[8:11], s70 offen offset:0 nt
    s_add_u32 s70, s70, 4096
    s_waitcnt vmcnt(4)
    v_mfma_f32_16x16x32_bf16 v[56:59], v[96:99], v[44:47], v[56:59]
    buffer_load_dwordx4 v[116:119], v2, s[8:11], s70 offen offset:0 nt
    s_add_u32 s70, s70, 4096
    s_waitcnt vmcnt(4)
    v_mfma_f32_16x16x32_bf16 v[56:59], v[100:103], v[48:51], v[56:59]
    buffer_load_dwordx4 v[120:123], v2, s[8:11], s70 offen offset:0 nt
    s_add_u32 s70, s70, 4096
    s_waitcnt vmcnt(4)
    v_mfma_f32_16x16x32_bf16 v[56:59], v[104:107], v[52:55], v[56:59]
    buffer_load_dwordx4 v[124:127], v2, s[8:11], s70 offen offset:0 nt
    s_add_u32 s70, s70, 4096
    s_waitcnt vmcnt(4)
    v_mfma_f32_16x16x32_bf16 v[60:63], v[108:111], v[40:43], 0
    buffer_load_dwordx4 v[128:131], v2, s[8:11], s70 offen offset:0 nt
    s_add_u32 s70, s70, 4096
    s_waitcnt vmcnt(4)
    v_mfma_f32_16x16x32_bf16 v[60:63], v[112:115], v[44:47], v[60:63]
    buffer_load_dwordx4 v[132:135], v2, s[8:11], s70 offen offset:0 nt
    s_add_u32 s70, s70, 4096
    s_waitcnt vmcnt(4)
    v_mfma_f32_16x16x32_bf16 v[60:63], v[116:119], v[48:51], v[60:63]
    buffer_load_dwordx4 v[136:139], v2, s[8:11], s70 offen offset:0 nt
    s_add_u32 s70, s70, 4096
    s_waitcnt vmcnt(4)
    v_mfma_f32_16x16x32_bf16 v[60:63], v[120:123], v[52:55], v[60:63]
    buffer_load_dwordx4 v[140:143], v2, s[8:11], s70 offen offset:0 nt
    s_add_u32 s70, s70, 4096
    s_waitcnt vmcnt(4)
    v_mfma_f32_16x16x32_bf16 v[64:67], v[124:127], v[40:43], 0
    buffer_load_dwordx4 v[144:147], v2, s[8:11], s70 offen offset:0 nt
    s_add_u32 s70, s70, 4096
    s_waitcnt vmcnt(4)
    v_mfma_f32_16x16x32_bf16 v[64:67], v[128:131], v[44:47], v[64:67]
    buffer_load_dwordx4 v[148:151], v2, s[8:11], s70 offen offset:0 nt
    s_add_u32 s70, s70, 4096
    s_waitcnt vmcnt(4)
    v_mfma_f32_16x16x32_bf16 v[64:67], v[132:135], v[48:51], v[64:67]
    buffer_load_dwordx4 v[152:155], v2, s[8:11], s70 offen offset:0 nt
    s_add_u32 s70, s70, 4096
    s_waitcnt vmcnt(4)
    v_mfma_f32_16x16x32_bf16 v[64:67], v[136:139], v[52:55], v[64:67]
    buffer_load_dwordx4 v[92:95], v2, s[8:11], s70 offen offset:0 nt
    s_add_u32 s70, s70, 4096
    s_waitcnt vmcnt(4)
    v_mfma_f32_16x16x32_bf16 v[68:71], v[140:143], v[40:43], 0
    buffer_load_dwordx4 v[96:99], v2, s[8:11], s70 offen offset:0 nt
    s_add_u32 s70, s70, 4096
    s_waitcnt vmcnt(4)
    v_mfma_f32_16x16x32_bf16 v[68:71], v[144:147], v[44:47], v[68:71]
    buffer_load_dwordx4 v[100:103], v2, s[8:11], s70 offen offset:0 nt
    s_add_u32 s70, s70, 4096
    s_waitcnt vmcnt(4)
    v_mfma_f32_16x16x32_bf16 v[68:71], v[148:151], v[48:51], v[68:71]
    buffer_load_dwordx4 v[104:107], v2, s[8:11], s70 offen offset:0 nt
    s_add_u32 s70, s70, 4096
    s_waitcnt vmcnt(4)
    v_mfma_f32_16x16x32_bf16 v[68:71], v[152:155], v[52:55], v[68:71]
    buffer_load_dwordx4 v[108:111], v2, s[8:11], s70 offen offset:0 nt
    s_add_u32 s70, s70, 4096
    s_nop 4
    v_add_f32_dpp v20, v57, v56 quad_perm:[1,1,1,1] row_mask:0xf bank_mask:0xf
    v_add_f32_dpp v21, v60, v61 quad_perm:[0,0,0,0] row_mask:0xf bank_mask:0xf
    v_add_f32_dpp v22, v64, v66 quad_perm:[0,0,0,0] row_mask:0xf bank_mask:0xf
    v_add_f32_dpp v23, v68, v71 quad_perm:[0,0,0,0] row_mask:0xf bank_mask:0xf
    v_add_f32_dpp v20, v58, v20 quad_perm:[2,2,2,2] row_mask:0xf bank_mask:0xf
    v_add_f32_dpp v21, v62, v21 quad_perm:[2,2,2,2] row_mask:0xf bank_mask:0xf
    v_add_f32_dpp v22, v65, v22 quad_perm:[1,1,1,1] row_mask:0xf bank_mask:0xf
    v_add_f32_dpp v23, v69, v23 quad_perm:[1,1,1,1] row_mask:0xf bank_mask:0xf
    v_add_f32_dpp v77, v59, v20 quad_perm:[3,3,3,3] row_mask:0xf bank_mask:0xf
    v_add_f32_dpp v21, v63, v21 quad_perm:[3,3,3,3] row_mask:0xf bank_mask:0xf
    v_add_f32_dpp v22, v67, v22 quad_perm:[3,3,3,3] row_mask:0xf bank_mask:0xf
    v_add_f32_dpp v23, v70, v23 quad_perm:[2,2,2,2] row_mask:0xf bank_mask:0xf
    v_cndmask_b32 v77, v77, v21, s[76:77]
    v_cndmask_b32 v77, v77, v22, s[78:79]
    v_cndmask_b32 v77, v77, v23, s[80:81]
    s_cmp_lg_u32 s66, 0
    s_cbranch_scc1 L_notag
    buffer_load_dword v15, v13, s[28:31], s87 offen sc1 nt
L_notag:
    s_mov_b32 s73, 0
    .p2align 3
L_kloop:
    s_waitcnt vmcnt(4)
    v_mfma_f32_16x16x32_bf16 v[56:59], v[92:95], v[40:43], 0
    buffer_load_dwordx4 v[112:115], v2, s[8:11], s70 offen offset:0 nt
    s_add_u32 s70, s70, 4096
    s_waitcnt vmcnt(4)
    v_mfma_f32_16x16x32_bf16 v[56:59], v[96:99], v[44:47], v[56:59]
    buffer_load_dwordx4 v[116:119], v2, s[8:11], s70 offen offset:0 nt
    s_add_u32 s70, s70, 4096
    s_waitcnt vmcnt(4)
    v_mfma_f32_16x16x32_bf16 v[56:59], v[100:103], v[48:51], v[56:59]
    buffer_load_dwordx4 v[120:123], v2, s[8:11], s70 offen offset:0 nt
    s_add_u32 s70, s70, 4096
    s_waitcnt vmcnt(4)
    v_mfma_f32_16x16x32_bf16 v[56:59], v[104:107], v[52:55], v[56:59]
    buffer_load_dwordx4 v[124:127], v2, s[8:11], s70 offen offset:0 nt
    s_add_u32 s70, s70, 4096
    s_waitcnt vmcnt(4)
    v_mfma_f32_16x16x32_bf16 v[60:63], v[108:111], v[40:43], 0
    buffer_load_dwordx4 v[128:131], v2, s[8:11], s70 offen offset:0 nt
    s_add_u32 s70, s70, 4096
    s_waitcnt vmcnt(4)
    v_mfma_f32_16x16x32_bf16 v[60:63], v[112:115], v[44:47], v[60:63]
    buffer_load_dwordx4 v[132:135], v2, s[8:11], s70 offen offset:0 nt
    s_add_u32 s70, s70, 4096
    s_waitcnt vmcnt(4)
    v_mfma_f32_16x16x32_bf16 v[60:63], v[116:119], v[48:51], v[60:63]
    buffer_load_dwordx4 v[136:139], v2, s[8:11], s70 offen offset:0 nt
    s_add_u32 s70, s70, 4096
    s_waitcnt vmcnt(4)
    v_mfma_f32_16x16x32_bf16 v[60:63], v[120:123], v[52:55], v[60:63]
    buffer_load_dwordx4 v[140:143], v2, s[8:11], s70 offen offset:0 nt
    s_add_u32 s70, s70, 4096
    s_waitcnt vmcnt(4)
    v_mfma_f32_16x16x32_bf16 v[64:67], v[124:127], v[40:43], 0
    buffer_load_dwordx4 v[144:147], v2, s[8:11], s70 offen offset:0 nt
    s_add_u32 s70, s70, 4096
    s_waitcnt vmcnt(4)
    v_mfma_f32_16x16x32_bf16 v[64:67], v[128:131], v[44:47], v[64:67]
    buffer_load_dwordx4 v[148:151], v2, s[8:11], s70 offen offset:0 nt
    s_add_u32 s70, s70, 4096
    s_waitcnt vmcnt(4)
    v_mfma_f32_16x16x32_bf16 v[64:67], v[132:135], v[48:51], v[64:67]
    buffer_load_dwordx4 v[152:155], v2, s[8:11], s70 offen offset:0 nt
    s_add_u32 s70, s70, 4096
    s_waitcnt vmcnt(4)
    v_mfma_f32_16x16x32_bf16 v[64:67], v[136:139], v[52:55], v[64:67]
    buffer_load_dwordx4 v[92:95], v2, s[8:11], s70 offen offset:0 nt
    s_add_u32 s70, s70, 4096
    s_waitcnt vmcnt(4)
    v_mfma_f32_16x16x32_bf16 v[68:71], v[140:143], v[40:43], 0
    buffer_load_dwordx4 v[96:99], v2, s[8:11], s70 offen offset:0 nt
    s_add_u32 s70, s70, 4096
    s_waitcnt vmcnt(4)
    v_mfma_f32_16x16x32_bf16 v[68:71], v[144:147], v[44:47], v[68:71]
    buffer_load_dwordx4 v[100:103], v2, s[8:11], s70 offen offset:0 nt
    s_add_u32 s70, s70, 4096
    s_waitcnt vmcnt(4)
    v_mfma_f32_16x16x32_bf16 v[68:71], v[148:151], v[48:51], v[68:71]
    buffer_load_dwordx4 v[104:107], v2, s[8:11], s70 offen offset:0 nt
    s_add_u32 s70, s70, 4096
    s_waitcnt vmcnt(4)
    v_mfma_f32_16x16x32_bf16 v[68:71], v[152:155], v[52:55], v[68:71]
    buffer_load_dwordx4 v[108:111], v2, s[8:11], s70 offen offset:0 nt
    s_add_u32 s70, s70, 4096
    v_mov_b32 v78, v79
    v_mov_b32 v79, v80
    v_mov_b32 v80, v81
    v_mov_b32 v81, v82
    v_mov_b32 v82, v83
    v_mov_b32 v83, v84
    v_add_f32_dpp v20, v57, v56 quad_perm:[1,1,1,1] row_mask:0xf bank_mask:0xf
    v_add_f32_dpp v21, v60, v61 quad_perm:[0,0,0,0] row_mask:0xf bank_mask:0xf
    v_add_f32_dpp v22, v64, v66 quad_perm:[0,0,0,0] row_mask:0xf bank_mask:0xf
    v_add_f32_dpp v23, v68, v71 quad_perm:[0,0,0,0] row_mask:0xf bank_mask:0xf
    v_add_f32_dpp v20, v58, v20 quad_perm:[2,2,2,2] row_mask:0xf bank_mask:0xf
    v_add_f32_dpp v21, v62, v21 quad_perm:[2,2,2,2] row_mask:0xf bank_mask:0xf
    v_add_f32_dpp v22, v65, v22 quad_perm:[1,1,1,1] row_mask:0xf bank_mask:0xf
    v_add_f32_dpp v23, v69, v23 quad_perm:[1,1,1,1] row_mask:0xf bank_mask:0xf
    v_add_f32_dpp v84, v59, v20 quad_perm:[3,3,3,3] row_mask:0xf bank_mask:0xf
    v_add_f32_dpp v21, v63, v21 quad_perm:[3,3,3,3] row_mask:0xf bank_mask:0xf
    v_add_f32_dpp v22, v67, v22 quad_perm:[3,3,3,3] row_mask:0xf bank_mask:0xf
    v_add_f32_dpp v23, v70, v23 quad_perm:[2,2,2,2] row_mask:0xf bank_mask:0xf
    v_cndmask_b32 v84, v84, v21, s[76:77]
    v_cndmask_b32 v84, v84, v22, s[78:79]
    v_cndmask_b32 v84, v84, v23, s[80:81]
    s_add_u32 s73, s73, 1
    s_cmp_lt_u32 s73, 7
    s_cbranch_scc1 L_kloop
    v_add_u32 v15, 0x5b, v15
    s_waitcnt vmcnt(4)
    v_mfma_f32_16x16x32_bf16 v[56:59], v[92:95], v[40:43], 0
    buffer_load_dwordx4 v[112:115], v2, s[8:11], s70 offen offset:0 nt
    s_add_u32 s70, s70, 4096
    buffer_load_dwordx4 a[0:3], v5, s[20:23], s95 offen
    s_add_u32 s95, s95, 4096
    s_waitcnt vmcnt(5)
    v_mfma_f32_16x16x32_bf16 v[56:59], v[96:99], v[44:47], v[56:59]
    buffer_load_dwordx4 v[116:119], v2, s[8:11], s70 offen offset:0 nt
    s_add_u32 s70, s70, 4096
    s_waitcnt vmcnt(5)
    v_mfma_f32_16x16x32_bf16 v[56:59], v[100:103], v[48:51], v[56:59]
    buffer_load_dwordx4 v[120:123], v2, s[8:11], s70 offen offset:0 nt
    s_add_u32 s70, s70, 4096
    buffer_load_dwordx4 a[4:7], v5, s[20:23], s95 offen
    s_add_u32 s95, s95, 4096
    s_waitcnt vmcnt(6)
    v_mfma_f32_16x16x32_bf16 v[56:59], v[104:107], v[52:55], v[56:59]
    buffer_load_dwordx4 v[124:127], v2, s[8:11], s70 offen offset:0 nt
    s_add_u32 s70, s70, 4096
    s_waitcnt vmcnt(6)
    v_mfma_f32_16x16x32_bf16 v[60:63], v[108:111], v[40:43], 0
    buffer_load_dwordx4 v[128:131], v2, s[8:11], s70 offen offset:0 nt
    s_add_u32 s70, s70, 4096
    buffer_load_dwordx4 a[8:11], v5, s[20:23], s95 offen
    s_add_u32 s95, s95, 4096
    s_waitcnt vmcnt(7)
    v_mfma_f32_16x16x32_bf16 v[60:63], v[112:115], v[44:47], v[60:63]
    buffer_load_dwordx4 v[132:135], v2, s[8:11], s70 offen offset:0 nt
    s_add_u32 s70, s70, 4096
    s_waitcnt vmcnt(6)
    v_mfma_f32_16x16x32_bf16 v[60:63], v[116:119], v[48:51], v[60:63]
    buffer_load_dwordx4 v[136:139], v2, s[8:11], s70 offen offset:0 nt
    s_add_u32 s70, s70, 4096
    buffer_load_dwordx4 a[12:15], v5, s[20:23], s95 offen
    s_add_u32 s95, s95, 4096
    s_waitcnt vmcnt(7)
    v_mfma_f32_16x16x32_bf16 v[60:63], v[120:123], v[52:55], v[60:63]
    buffer_load_dwordx4 v[140:143], v2, s[8:11], s70 offen offset:0 nt
    s_add_u32 s70, s70, 4096
    s_waitcnt vmcnt(6)
    v_mfma_f32_16x16x32_bf16 v[64:67], v[124:127], v[40:43], 0
    buffer_load_dwordx4 v[144:147], v2, s[8:11], s70 offen offset:0 nt
    s_add_u32 s70, s70, 4096
    buffer_load_dwordx4 a[16:19], v5, s[20:23], s95 offen
    s_add_u32 s95, s95, 4096
    s_waitcnt vmcnt(7)
    v_mfma_f32_16x16x32_bf16 v[64:67], v[128:131], v[44:47], v[64:67]
    buffer_load_dwordx4 v[148:151], v2, s[8:11], s70 offen offset:0 nt
    s_add_u32 s70, s70, 4096
    s_waitcnt vmcnt(6)
    v_mfma_f32_16x16x32_bf16 v[64:67], v[132:135], v[48:51], v[64:67]
    buffer_load_dwordx4 v[152:155], v2, s[8:11], s70 offen offset:0 nt
    s_add_u32 s70, s70, 4096
    buffer_load_dwordx4 a[20:23], v5, s[20:23], s95 offen
    s_add_u32 s95, s95, 4096
    s_waitcnt vmcnt(7)
    v_mfma_f32_16x16x32_bf16 v[64:67], v[136:139], v[52:55], v[64:67]
    buffer_load_dwordx4 v[92:95], v2, s[8:11], s70 offen offset:0 nt
    s_add_u32 s70, s70, 4096
    s_waitcnt vmcnt(6)
    v_mfma_f32_16x16x32_bf16 v[68:71], v[140:143], v[40:43], 0
    buffer_load_dwordx4 v[96:99], v2, s[8:11], s70 offen offset:0 nt
    s_add_u32 s70, s70, 4096
    buffer_load_dwordx4 a[24:27], v5, s[20:23], s95 offen
    s_add_u32 s95, s95, 4096
    s_waitcnt vmcnt(7)
    v_mfma_f32_16x16x32_bf16 v[68:71], v[144:147], v[44:47], v[68:71]
    buffer_load_dwordx4 v[100:103], v2, s[8:11], s70 offen offset:0 nt
    s_add_u32 s70, s70, 4096
    s_waitcnt vmcnt(6)
    v_mfma_f32_16x16x32_bf16 v[68:71], v[148:151], v[48:51], v[68:71]
    buffer_load_dwordx4 v[104:107], v2, s[8:11], s70 offen offset:0 nt
    s_add_u32 s70, s70, 4096
    buffer_load_dwordx4 a[28:31], v5, s[20:23], s95 offen
    s_add_u32 s95, s95, 4096
    s_cmp_eq_u32 s95, 131072
    s_cselect_b32 s95, 0, s95
    s_waitcnt vmcnt(7)
    v_mfma_f32_16x16x32_bf16 v[68:71], v[152:155], v[52:55], v[68:71]
    buffer_load_dwordx4 v[108:111], v2, s[8:11], s70 offen offset:0 nt
    s_add_u32 s70, s70, 4096
    s_nop 4
    v_add_f32_dpp v20, v57, v56 quad_perm:[1,1,1,1] row_mask:0xf bank_mask:0xf
    v_add_f32_dpp v21, v60, v61 quad_perm:[0,0,0,0] row_mask:0xf bank_mask:0xf
    v_add_f32_dpp v22, v64, v66 quad_perm:[0,0,0,0] row_mask:0xf bank_mask:0xf
    v_add_f32_dpp v23, v68, v71 quad_perm:[0,0,0,0] row_mask:0xf bank_mask:0xf
    v_add_f32_dpp v20, v58, v20 quad_perm:[2,2,2,2] row_mask:0xf bank_mask:0xf
    v_add_f32_dpp v21, v62, v21 quad_perm:[2,2,2,2] row_mask:0xf bank_mask:0xf
    v_add_f32_dpp v22, v65, v22 quad_perm:[1,1,1,1] row_mask:0xf bank_mask:0xf
    v_add_f32_dpp v23, v69, v23 quad_perm:[1,1,1,1] row_mask:0xf bank_mask:0xf
    v_add_f32_dpp v85, v59, v20 quad_perm:[3,3,3,3] row_mask:0xf bank_mask:0xf
    v_add_f32_dpp v21, v63, v21 quad_perm:[3,3,3,3] row_mask:0xf bank_mask:0xf
    v_add_f32_dpp v22, v67, v22 quad_perm:[3,3,3,3] row_mask:0xf bank_mask:0xf
    v_add_f32_dpp v23, v70, v23 quad_perm:[2,2,2,2] row_mask:0xf bank_mask:0xf
    v_cndmask_b32 v85, v85, v21, s[76:77]
    v_cndmask_b32 v85, v85, v22, s[78:79]
    v_cndmask_b32 v85, v85, v23, s[80:81]
    s_waitcnt vmcnt(6)
    v_mfma_f32_16x16x32_bf16 v[56:59], v[92:95], v[40:43], 0
    buffer_load_dwordx4 v[112:115], v2, s[8:11], s70 offen offset:0 nt
    s_add_u32 s70, s70, 4096
    buffer_load_dwordx4 a[32:35], v5, s[20:23], s95 offen
    s_add_u32 s95, s95, 4096
    s_waitcnt vmcnt(7)
    v_mfma_f32_16x16x32_bf16 v[56:59], v[96:99], v[44:47], v[56:59]
    buffer_load_dwordx4 v[116:119], v2, s[8:11], s70 offen offset:0 nt
    s_add_u32 s70, s70, 4096
    s_waitcnt vmcnt(6)
    v_mfma_f32_16x16x32_bf16 v[56:59], v[100:103], v[48:51], v[56:59]
    buffer_load_dwordx4 v[120:123], v2, s[8:11], s70 offen offset:0 nt
    s_add_u32 s70, s70, 4096
    buffer_load_dwordx4 a[36:39], v5, s[20:23], s95 offen
    s_add_u32 s95, s95, 4096
    s_waitcnt vmcnt(7)
    v_mfma_f32_16x16x32_bf16 v[56:59], v[104:107], v[52:55], v[56:59]
    buffer_load_dwordx4 v[124:127], v2, s[8:11], s70 offen offset:0 nt
    s_add_u32 s70, s70, 4096
    s_waitcnt vmcnt(6)
    v_mfma_f32_16x16x32_bf16 v[60:63], v[108:111], v[40:43], 0
    buffer_load_dwordx4 v[128:131], v2, s[8:11], s70 offen offset:0 nt
    s_add_u32 s70, s70, 4096
    buffer_load_dwordx4 a[40:43], v5, s[20:23], s95 offen
    s_add_u32 s95, s95, 4096
    s_waitcnt vmcnt(7)
    v_mfma_f32_16x16x32_bf16 v[60:63], v[112:115], v[44:47], v[60:63]
    buffer_load_dwordx4 v[132:135], v2, s[8:11], s70 offen offset:0 nt
    s_add_u32 s70, s70, 4096
    s_waitcnt vmcnt(6)
    v_mfma_f32_16x16x32_bf16 v[60:63], v[116:119], v[48:51], v[60:63]
    buffer_load_dwordx4 v[136:139], v2, s[8:11], s70 offen offset:0 nt
    s_add_u32 s70, s70, 4096
    buffer_load_dwordx4 a[44:47], v5, s[20:23], s95 offen
    s_add_u32 s95, s95, 4096
    s_waitcnt vmcnt(7)
    v_mfma_f32_16x16x32_bf16 v[60:63], v[120:123], v[52:55], v[60:63]
    buffer_load_dwordx4 v[140:143], v2, s[8:11], s70 offen offset:0 nt
    s_add_u32 s70, s70, 4096
    s_waitcnt vmcnt(6)
    v_mfma_f32_16x16x32_bf16 v[64:67], v[124:127], v[40:43], 0
    buffer_load_dwordx4 v[144:147], v2, s[8:11], s70 offen offset:0 nt
    s_add_u32 s70, s70, 4096
    buffer_load_dwordx4 a[48:51], v5, s[20:23], s95 offen
    s_add_u32 s95, s95, 4096
    s_waitcnt vmcnt(7)
    v_mfma_f32_16x16x32_bf16 v[64:67], v[128:131], v[44:47], v[64:67]
    buffer_load_dwordx4 v[148:151], v2, s[8:11], s70 offen offset:0 nt
    s_add_u32 s70, s70, 4096
    s_waitcnt vmcnt(6)
    v_mfma_f32_16x16x32_bf16 v[64:67], v[132:135], v[48:51], v[64:67]
    buffer_load_dwordx4 v[152:155], v2, s[8:11], s70 offen offset:0 nt
    s_add_u32 s70, s70, 4096
    buffer_load_dwordx4 a[52:55], v5, s[20:23], s95 offen
    s_add_u32 s95, s95, 4096
    s_waitcnt vmcnt(7)
    v_mfma_f32_16x16x32_bf16 v[64:67], v[136:139], v[52:55], v[64:67]
    buffer_load_dwordx4 v[92:95], v2, s[8:11], s70 offen offset:0 nt
    s_add_u32 s70, s70, 4096
    s_waitcnt vmcnt(6)
    v_mfma_f32_16x16x32_bf16 v[68:71], v[140:143], v[40:43], 0
    buffer_load_dwordx4 v[96:99], v2, s[8:11], s70 offen offset:0 nt
    s_add_u32 s70, s70, 4096
    buffer_load_dwordx4 a[56:59], v5, s[20:23], s95 offen
    s_add_u32 s95, s95, 4096
    s_waitcnt vmcnt(7)
    v_mfma_f32_16x16x32_bf16 v[68:71], v[144:147], v[44:47], v[68:71]
    buffer_load_dwordx4 v[100:103], v2, s[8:11], s70 offen offset:0 nt
    s_add_u32 s70, s70, 4096
    s_waitcnt vmcnt(6)
    v_mfma_f32_16x16x32_bf16 v[68:71], v[148:151], v[48:51], v[68:71]
    buffer_load_dwordx4 v[104:107], v2, s[8:11], s70 offen offset:0 nt
    s_add_u32 s70, s70, 4096
    buffer_load_dwordx4 a[60:63], v5, s[20:23], s95 offen
    s_add_u32 s95, s95, 4096
    s_cmp_eq_u32 s95, 131072
    s_cselect_b32 s95, 0, s95
    s_waitcnt vmcnt(7)
    v_mfma_f32_16x16x32_bf16 v[68:71], v[152:155], v[52:55], v[68:71]
    buffer_load_dwordx4 v[108:111], v2, s[8:11], s70 offen offset:0 nt
    s_add_u32 s70, s70, 4096
    s_nop 4
    v_add_f32_dpp v20, v57, v56 quad_perm:[1,1,1,1] row_mask:0xf bank_mask:0xf
    v_add_f32_dpp v21, v60, v61 quad_perm:[0,0,0,0] row_mask:0xf bank_mask:0xf
    v_add_f32_dpp v22, v64, v66 quad_perm:[0,0,0,0] row_mask:0xf bank_mask:0xf
    v_add_f32_dpp v23, v68, v71 quad_perm:[0,0,0,0] row_mask:0xf bank_mask:0xf
    v_add_f32_dpp v20, v58, v20 quad_perm:[2,2,2,2] row_mask:0xf bank_mask:0xf
    v_add_f32_dpp v21, v62, v21 quad_perm:[2,2,2,2] row_mask:0xf bank_mask:0xf
    v_add_f32_dpp v22, v65, v22 quad_perm:[1,1,1,1] row_mask:0xf bank_mask:0xf
    v_add_f32_dpp v23, v69, v23 quad_perm:[1,1,1,1] row_mask:0xf bank_mask:0xf
    v_add_f32_dpp v86, v59, v20 quad_perm:[3,3,3,3] row_mask:0xf bank_mask:0xf
    v_add_f32_dpp v21, v63, v21 quad_perm:[3,3,3,3] row_mask:0xf bank_mask:0xf
    v_add_f32_dpp v22, v67, v22 quad_perm:[3,3,3,3] row_mask:0xf bank_mask:0xf
    v_add_f32_dpp v23, v70, v23 quad_perm:[2,2,2,2] row_mask:0xf bank_mask:0xf
    v_cndmask_b32 v86, v86, v21, s[76:77]
    v_cndmask_b32 v86, v86, v22, s[78:79]
    v_cndmask_b32 v86, v86, v23, s[80:81]
    s_waitcnt vmcnt(6)
    v_mfma_f32_16x16x32_bf16 v[56:59], v[92:95], v[40:43], 0
    buffer_load_dwordx4 v[112:115], v2, s[8:11], s70 offen offset:0 nt
    s_add_u32 s70, s70, 4096
    buffer_load_dwordx4 a[64:67], v5, s[20:23], s95 offen
    s_add_u32 s95, s95, 4096
    s_waitcnt vmcnt(7)
    v_mfma_f32_16x16x32_bf16 v[56:59], v[96:99], v[44:47], v[56:59]
    buffer_load_dwordx4 v[116:119], v2, s[8:11], s70 offen offset:0 nt
    s_add_u32 s70, s70, 4096
    s_waitcnt vmcnt(6)
    v_mfma_f32_16x16x32_bf16 v[56:59], v[100:103], v[48:51], v[56:59]
    buffer_load_dwordx4 v[120:123], v2, s[8:11], s70 offen offset:0 nt
    s_add_u32 s70, s70, 4096
    buffer_load_dwordx4 a[68:71], v5, s[20:23], s95 offen
    s_add_u32 s95, s95, 4096
    s_waitcnt vmcnt(7)
    v_mfma_f32_16x16x32_bf16 v[56:59], v[104:107], v[52:55], v[56:59]
    buffer_load_dwordx4 v[124:127], v2, s[8:11], s70 offen offset:0 nt
    s_add_u32 s70, s70, 4096
    s_waitcnt vmcnt(6)
    v_mfma_f32_16x16x32_bf16 v[60:63], v[108:111], v[40:43], 0
    buffer_load_dwordx4 v[128:131], v2, s[8:11], s70 offen offset:0 nt
    s_add_u32 s70, s70, 4096
    buffer_load_dwordx4 a[72:75], v5, s[20:23], s95 offen
    s_add_u32 s95, s95, 4096
    s_waitcnt vmcnt(7)
    v_mfma_f32_16x16x32_bf16 v[60:63], v[112:115], v[44:47], v[60:63]
    buffer_load_dwordx4 v[132:135], v2, s[8:11], s70 offen offset:0 nt
    s_add_u32 s70, s70, 4096
    s_waitcnt vmcnt(6)
    v_mfma_f32_16x16x32_bf16 v[60:63], v[116:119], v[48:51], v[60:63]
    buffer_load_dwordx4 v[136:139], v2, s[8:11], s70 offen offset:0 nt
    s_add_u32 s70, s70, 4096
    buffer_load_dwordx4 a[76:79], v5, s[20:23], s95 offen
    s_add_u32 s95, s95, 4096
    s_waitcnt vmcnt(7)
    v_mfma_f32_16x16x32_bf16 v[60:63], v[120:123], v[52:55], v[60:63]
    buffer_load_dwordx4 v[140:143], v2, s[8:11], s70 offen offset:0 nt
    s_add_u32 s70, s70, 4096
    s_waitcnt vmcnt(6)
    v_mfma_f32_16x16x32_bf16 v[64:67], v[124:127], v[40:43], 0
    buffer_load_dwordx4 v[144:147], v2, s[8:11], s70 offen offset:0 nt
    s_add_u32 s70, s70, 4096
    buffer_load_dwordx4 a[80:83], v5, s[20:23], s95 offen
    s_add_u32 s95, s95, 4096
    s_waitcnt vmcnt(7)
    v_mfma_f32_16x16x32_bf16 v[64:67], v[128:131], v[44:47], v[64:67]
    buffer_load_dwordx4 v[148:151], v2, s[8:11], s70 offen offset:0 nt
    s_add_u32 s70, s70, 4096
    s_waitcnt vmcnt(6)
    v_mfma_f32_16x16x32_bf16 v[64:67], v[132:135], v[48:51], v[64:67]
    buffer_load_dwordx4 v[152:155], v2, s[8:11], s70 offen offset:0 nt
    s_add_u32 s70, s70, 4096
    buffer_load_dwordx4 a[84:87], v5, s[20:23], s95 offen
    s_add_u32 s95, s95, 4096
    s_waitcnt vmcnt(7)
    v_mfma_f32_16x16x32_bf16 v[64:67], v[136:139], v[52:55], v[64:67]
    buffer_load_dwordx4 v[92:95], v3, s[12:15], s71 offen offset:0 nt
    s_add_u32 s71, s71, 4096
    s_waitcnt vmcnt(6)
    v_mfma_f32_16x16x32_bf16 v[68:71], v[140:143], v[40:43], 0
    buffer_load_dwordx4 v[96:99], v3, s[12:15], s71 offen offset:0 nt
    s_add_u32 s71, s71, 4096
    buffer_load_dwordx4 a[88:91], v5, s[20:23], s95 offen
    s_add_u32 s95, s95, 4096
    s_waitcnt vmcnt(7)
    v_mfma_f32_16x16x32_bf16 v[68:71], v[144:147], v[44:47], v[68:71]
    buffer_load_dwordx4 v[100:103], v3, s[12:15], s71 offen offset:0 nt
    s_add_u32 s71, s71, 4096
    s_waitcnt vmcnt(6)
    v_mfma_f32_16x16x32_bf16 v[68:71], v[148:151], v[48:51], v[68:71]
    buffer_load_dwordx4 v[104:107], v3, s[12:15], s71 offen offset:0 nt
    s_add_u32 s71, s71, 4096
    buffer_load_dwordx4 a[92:95], v5, s[20:23], s95 offen
    s_add_u32 s95, s95, 4096
    s_cmp_eq_u32 s95, 131072
    s_cselect_b32 s95, 0, s95
    s_waitcnt vmcnt(7)
    v_mfma_f32_16x16x32_bf16 v[68:71], v[152:155], v[52:55], v[68:71]
    buffer_load_dwordx4 v[108:111], v3, s[12:15], s71 offen offset:0 nt
    s_add_u32 s71, s71, 4096
    s_nop 4
    v_add_f32_dpp v20, v57, v56 quad_perm:[1,1,1,1] row_mask:0xf bank_mask:0xf
    v_add_f32_dpp v21, v60, v61 quad_perm:[0,0,0,0] row_mask:0xf bank_mask:0xf
    v_add_f32_dpp v22, v64, v66 quad_perm:[0,0,0,0] row_mask:0xf bank_mask:0xf
    v_add_f32_dpp v23, v68, v71 quad_perm:[0,0,0,0] row_mask:0xf bank_mask:0xf
    v_add_f32_dpp v20, v58, v20 quad_perm:[2,2,2,2] row_mask:0xf bank_mask:0xf
    v_add_f32_dpp v21, v62, v21 quad_perm:[2,2,2,2] row_mask:0xf bank_mask:0xf
    v_add_f32_dpp v22, v65, v22 quad_perm:[1,1,1,1] row_mask:0xf bank_mask:0xf
    v_add_f32_dpp v23, v69, v23 quad_perm:[1,1,1,1] row_mask:0xf bank_mask:0xf
    v_add_f32_dpp v87, v59, v20 quad_perm:[3,3,3,3] row_mask:0xf bank_mask:0xf
    v_add_f32_dpp v21, v63, v21 quad_perm:[3,3,3,3] row_mask:0xf bank_mask:0xf
    v_add_f32_dpp v22, v67, v22 quad_perm:[3,3,3,3] row_mask:0xf bank_mask:0xf
    v_add_f32_dpp v23, v70, v23 quad_perm:[2,2,2,2] row_mask:0xf bank_mask:0xf
    v_cndmask_b32 v87, v87, v21, s[76:77]
    v_cndmask_b32 v87, v87, v22, s[78:79]
    v_cndmask_b32 v87, v87, v23, s[80:81]
    v_max3_f32 v56, v72, v73, v74
    v_max3_f32 v57, v75, v76, v77
    v_max3_f32 v58, v78, v79, v80
    v_max3_f32 v59, v81, v82, v83
    v_max3_f32 v56, v56, v84, v85
    v_max3_f32 v57, v57, v86, v87
    v_max3_f32 v56, v56, v57, v58
    v_max_f32 v56, v56, v59
    s_nop 1
    v_max_f32_dpp v56, v56, v56 row_ror:8 row_mask:0xf bank_mask:0xf
    s_nop 1
    v_max_f32_dpp v56, v56, v56 row_ror:4 row_mask:0xf bank_mask:0xf
    s_nop 1
    v_max_f32_dpp v56, v56, v56 row_ror:2 row_mask:0xf bank_mask:0xf
    s_nop 1
    v_max_f32_dpp v56, v56, v56 row_ror:1 row_mask:0xf bank_mask:0xf
    s_nop 1
    v_max_f32_dpp v56, v56, v56 row_bcast:15 row_mask:0xa bank_mask:0xf
    s_nop 1
    v_max_f32_dpp v56, v56, v56 row_bcast:31 row_mask:0xc bank_mask:0xf
    s_nop 0
    v_readlane_b32 s82, v56, 63
    s_waitcnt vmcnt(6)
    buffer_load_dwordx4 v[112:115], v3, s[12:15], s71 offen offset:0 nt
    s_add_u32 s71, s71, 4096
    buffer_load_dwordx4 a[96:99], v5, s[20:23], s95 offen
    s_add_u32 s95, s95, 4096
    s_nop 1
    v_mov_b32 v14, s82
    v_mul_f32 v14, s83, v14
    v_fma_f32 v72, v72, s83, -v14
    v_fma_f32 v73, v73, s83, -v14
    v_fma_f32 v74, v74, s83, -v14
    v_fma_f32 v75, v75, s83, -v14
    v_fma_f32 v76, v76, s83, -v14
    v_fma_f32 v77, v77, s83, -v14
    v_fma_f32 v78, v78, s83, -v14
    v_fma_f32 v79, v79, s83, -v14
    v_fma_f32 v80, v80, s83, -v14
    v_fma_f32 v81, v81, s83, -v14
    v_fma_f32 v82, v82, s83, -v14
    v_fma_f32 v83, v83, s83, -v14
    v_fma_f32 v84, v84, s83, -v14
    v_fma_f32 v85, v85, s83, -v14
    v_fma_f32 v86, v86, s83, -v14
    v_fma_f32 v87, v87, s83, -v14
    v_exp_f32 v72, v72
    v_exp_f32 v73, v73
    v_exp_f32 v74, v74
    v_exp_f32 v75, v75
    v_exp_f32 v76, v76
    v_exp_f32 v77, v77
    v_exp_f32 v78, v78
    v_exp_f32 v79, v79
    v_exp_f32 v80, v80
    v_exp_f32 v81, v81
    v_exp_f32 v82, v82
    v_exp_f32 v83, v83
    v_exp_f32 v84, v84
    v_exp_f32 v85, v85
    v_exp_f32 v86, v86
    v_exp_f32 v87, v87
    s_waitcnt vmcnt(7)
    buffer_load_dwordx4 v[116:119], v3, s[12:15], s71 offen offset:0 nt
    s_add_u32 s71, s71, 4096
    s_nop 0
    v_cvt_pk_bf16_f32 v72, v72, v72
    v_cvt_pk_bf16_f32 v73, v73, v73
    v_cvt_pk_bf16_f32 v74, v74, v74
    v_cvt_pk_bf16_f32 v75, v75, v75
    v_cvt_pk_bf16_f32 v76, v76, v76
    v_cvt_pk_bf16_f32 v77, v77, v77
    v_cvt_pk_bf16_f32 v78, v78, v78
    v_cvt_pk_bf16_f32 v79, v79, v79
    v_cvt_pk_bf16_f32 v80, v80, v80
    v_cvt_pk_bf16_f32 v81, v81, v81
    v_cvt_pk_bf16_f32 v82, v82, v82
    v_cvt_pk_bf16_f32 v83, v83, v83
    v_cvt_pk_bf16_f32 v84, v84, v84
    v_cvt_pk_bf16_f32 v85, v85, v85
    v_cvt_pk_bf16_f32 v86, v86, v86
    v_cvt_pk_bf16_f32 v87, v87, v87
    v_lshlrev_b32 v56, 16, v72
    v_lshlrev_b32 v57, 16, v73
    v_lshlrev_b32 v58, 16, v74
    v_lshlrev_b32 v59, 16, v75
    v_lshlrev_b32 v60, 16, v76
    v_lshlrev_b32 v61, 16, v77
    v_lshlrev_b32 v62, 16, v78
    v_lshlrev_b32 v63, 16, v79
    v_lshlrev_b32 v64, 16, v80
    v_lshlrev_b32 v65, 16, v81
    v_lshlrev_b32 v66, 16, v82
    v_lshlrev_b32 v67, 16, v83
    v_lshlrev_b32 v68, 16, v84
    v_lshlrev_b32 v69, 16, v85
    v_lshlrev_b32 v70, 16, v86
    v_lshlrev_b32 v71, 16, v87
    v_add_f32 v56, v56, v64
    v_add_f32 v57, v57, v65
    v_add_f32 v58, v58, v66
    v_add_f32 v59, v59, v67
    v_add_f32 v60, v60, v68
    v_add_f32 v61, v61, v69
    v_add_f32 v62, v62, v70
    v_add_f32 v63, v63, v71
    v_add_f32 v56, v56, v60
    v_add_f32 v57, v57, v61
    v_add_f32 v58, v58, v62
    v_add_f32 v59, v59, v63
    v_add_f32 v56, v56, v58
    v_add_f32 v57, v57, v59
    v_add_f32 v56, v56, v57
    s_waitcnt vmcnt(6)
    buffer_load_dwordx4 v[120:123], v3, s[12:15], s71 offen offset:0 nt
    s_add_u32 s71, s71, 4096
    buffer_load_dwordx4 a[100:103], v5, s[20:23], s95 offen
    s_add_u32 s95, s95, 4096
    s_nop 1
    v_add_f32_dpp v56, v56, v56 row_ror:8 row_mask:0xf bank_mask:0xf
    s_nop 1
    v_add_f32_dpp v56, v56, v56 row_ror:4 row_mask:0xf bank_mask:0xf
    s_nop 1
    v_add_f32_dpp v56, v56, v56 row_ror:2 row_mask:0xf bank_mask:0xf
    s_nop 1
    v_add_f32_dpp v56, v56, v56 row_ror:1 row_mask:0xf bank_mask:0xf
    s_nop 1
    v_add_f32_dpp v56, v56, v56 row_bcast:15 row_mask:0xa bank_mask:0xf
    s_nop 1
    v_add_f32_dpp v56, v56, v56 row_bcast:31 row_mask:0xc bank_mask:0xf
    s_mov_b32 exec_lo, 0
    s_mov_b32 exec_hi, 0x80000000
    ds_write_b32 v17, v14 offset:3072
    ds_write_b32 v17, v56 offset:3088
    ds_write_b32 v17, v15 offset:3104
    s_mov_b64 exec, -1
    v_and_b32_dpp v28, v72, v24 row_newbcast:0 row_mask:0xf bank_mask:0xf
    v_and_b32_dpp v29, v72, v25 row_newbcast:0 row_mask:0xf bank_mask:0xf
    v_and_b32_dpp v30, v72, v26 row_newbcast:0 row_mask:0xf bank_mask:0xf
    v_and_b32_dpp v31, v72, v27 row_newbcast:0 row_mask:0xf bank_mask:0xf
    v_and_b32_dpp v32, v72, v24 row_newbcast:4 row_mask:0xf bank_mask:0xf
    v_and_b32_dpp v33, v72, v25 row_newbcast:4 row_mask:0xf bank_mask:0xf
    v_and_b32_dpp v34, v72, v26 row_newbcast:4 row_mask:0xf bank_mask:0xf
    v_and_b32_dpp v35, v72, v27 row_newbcast:4 row_mask:0xf bank_mask:0xf
    v_mfma_f32_16x16x32_bf16 v[36:39], v[28:31], v[92:95], 0
    v_and_b32_dpp v28, v72, v24 row_newbcast:8 row_mask:0xf bank_mask:0xf
    v_and_b32_dpp v29, v72, v25 row_newbcast:8 row_mask:0xf bank_mask:0xf
    v_and_b32_dpp v30, v72, v26 row_newbcast:8 row_mask:0xf bank_mask:0xf
    v_and_b32_dpp v31, v72, v27 row_newbcast:8 row_mask:0xf bank_mask:0xf
    v_mfma_f32_16x16x32_bf16 v[36:39], v[32:35], v[96:99], v[36:39]
    v_and_b32_dpp v32, v72, v24 row_newbcast:12 row_mask:0xf bank_mask:0xf
    v_and_b32_dpp v33, v72, v25 row_newbcast:12 row_mask:0xf bank_mask:0xf
    v_and_b32_dpp v34, v72, v26 row_newbcast:12 row_mask:0xf bank_mask:0xf
    v_and_b32_dpp v35, v72, v27 row_newbcast:12 row_mask:0xf bank_mask:0xf
    v_mfma_f32_16x16x32_bf16 v[36:39], v[28:31], v[100:103], v[36:39]
    v_and_b32_dpp v28, v72, v24 row_newbcast:1 row_mask:0xf bank_mask:0xf
    v_and_b32_dpp v29, v72, v25 row_newbcast:1 row_mask:0xf bank_mask:0xf
    v_and_b32_dpp v30, v72, v26 row_newbcast:1 row_mask:0xf bank_mask:0xf
    v_and_b32_dpp v31, v72, v27 row_newbcast:1 row_mask:0xf bank_mask:0xf
    s_waitcnt vmcnt(7)
    v_mfma_f32_16x16x32_bf16 v[36:39], v[32:35], v[104:107], v[36:39]
    buffer_load_dwordx4 v[124:127], v3, s[12:15], s71 offen offset:0 nt
    s_add_u32 s71, s71, 4096
    v_and_b32_dpp v32, v72, v24 row_newbcast:5 row_mask:0xf bank_mask:0xf
    v_and_b32_dpp v33, v72, v25 row_newbcast:5 row_mask:0xf bank_mask:0xf
    v_and_b32_dpp v34, v72, v26 row_newbcast:5 row_mask:0xf bank_mask:0xf
    v_and_b32_dpp v35, v72, v27 row_newbcast:5 row_mask:0xf bank_mask:0xf
    s_waitcnt vmcnt(6)
    v_mfma_f32_16x16x32_bf16 v[36:39], v[28:31], v[108:111], v[36:39]
    buffer_load_dwordx4 v[128:131], v3, s[12:15], s71 offen offset:0 nt
    s_add_u32 s71, s71, 4096
    buffer_load_dwordx4 a[104:107], v5, s[20:23], s95 offen
    s_add_u32 s95, s95, 4096
    v_and_b32_dpp v28, v72, v24 row_newbcast:9 row_mask:0xf bank_mask:0xf
    v_and_b32_dpp v29, v72, v25 row_newbcast:9 row_mask:0xf bank_mask:0xf
    v_and_b32_dpp v30, v72, v26 row_newbcast:9 row_mask:0xf bank_mask:0xf
    v_and_b32_dpp v31, v72, v27 row_newbcast:9 row_mask:0xf bank_mask:0xf
    s_waitcnt vmcnt(7)
    v_mfma_f32_16x16x32_bf16 v[36:39], v[32:35], v[112:115], v[36:39]
    buffer_load_dwordx4 v[132:135], v3, s[12:15], s71 offen offset:0 nt
    s_add_u32 s71, s71, 4096
    v_and_b32_dpp v32, v72, v24 row_newbcast:13 row_mask:0xf bank_mask:0xf
    v_and_b32_dpp v33, v72, v25 row_newbcast:13 row_mask:0xf bank_mask:0xf
    v_and_b32_dpp v34, v72, v26 row_newbcast:13 row_mask:0xf bank_mask:0xf
    v_and_b32_dpp v35, v72, v27 row_newbcast:13 row_mask:0xf bank_mask:0xf
    s_waitcnt vmcnt(6)
    v_mfma_f32_16x16x32_bf16 v[36:39], v[28:31], v[116:119], v[36:39]
    buffer_load_dwordx4 v[136:139], v3, s[12:15], s71 offen offset:0 nt
    s_add_u32 s71, s71, 4096
    buffer_load_dwordx4 a[108:111], v5, s[20:23], s95 offen
    s_add_u32 s95, s95, 4096
    v_and_b32_dpp v28, v72, v24 row_newbcast:2 row_mask:0xf bank_mask:0xf
    v_and_b32_dpp v29, v72, v25 row_newbcast:2 row_mask:0xf bank_mask:0xf
    v_and_b32_dpp v30, v72, v26 row_newbcast:2 row_mask:0xf bank_mask:0xf
    v_and_b32_dpp v31, v72, v27 row_newbcast:2 row_mask:0xf bank_mask:0xf
    s_waitcnt vmcnt(7)
    v_mfma_f32_16x16x32_bf16 v[36:39], v[32:35], v[120:123], v[36:39]
    buffer_load_dwordx4 v[140:143], v3, s[12:15], s71 offen offset:0 nt
    s_add_u32 s71, s71, 4096
    v_and_b32_dpp v32, v72, v24 row_newbcast:6 row_mask:0xf bank_mask:0xf
    v_and_b32_dpp v33, v72, v25 row_newbcast:6 row_mask:0xf bank_mask:0xf
    v_and_b32_dpp v34, v72, v26 row_newbcast:6 row_mask:0xf bank_mask:0xf
    v_and_b32_dpp v35, v72, v27 row_newbcast:6 row_mask:0xf bank_mask:0xf
    s_waitcnt vmcnt(6)
    v_mfma_f32_16x16x32_bf16 v[36:39], v[28:31], v[124:127], v[36:39]
    buffer_load_dwordx4 v[144:147], v3, s[12:15], s71 offen offset:0 nt
    s_add_u32 s71, s71, 4096
    buffer_load_dwordx4 a[112:115], v5, s[20:23], s95 offen
    s_add_u32 s95, s95, 4096
    v_and_b32_dpp v28, v72, v24 row_newbcast:10 row_mask:0xf bank_mask:0xf
    v_and_b32_dpp v29, v72, v25 row_newbcast:10 row_mask:0xf bank_mask:0xf
    v_and_b32_dpp v30, v72, v26 row_newbcast:10 row_mask:0xf bank_mask:0xf
    v_and_b32_dpp v31, v72, v27 row_newbcast:10 row_mask:0xf bank_mask:0xf
    s_waitcnt vmcnt(7)
    v_mfma_f32_16x16x32_bf16 v[36:39], v[32:35], v[128:131], v[36:39]
    buffer_load_dwordx4 v[148:151], v3, s[12:15], s71 offen offset:0 nt
    s_add_u32 s71, s71, 4096
    v_and_b32_dpp v32, v72, v24 row_newbcast:14 row_mask:0xf bank_mask:0xf
    v_and_b32_dpp v33, v72, v25 row_newbcast:14 row_mask:0xf bank_mask:0xf
    v_and_b32_dpp v34, v72, v26 row_newbcast:14 row_mask:0xf bank_mask:0xf
    v_and_b32_dpp v35, v72, v27 row_newbcast:14 row_mask:0xf bank_mask:0xf
    s_waitcnt vmcnt(6)
    v_mfma_f32_16x16x32_bf16 v[36:39], v[28:31], v[132:135], v[36:39]
    buffer_load_dwordx4 v[152:155], v3, s[12:15], s71 offen offset:0 nt
    s_add_u32 s71, s71, 4096
    buffer_load_dwordx4 a[116:119], v5, s[20:23], s95 offen
    s_add_u32 s95, s95, 4096
    v_and_b32_dpp v28, v72, v24 row_newbcast:3 row_mask:0xf bank_mask:0xf
    v_and_b32_dpp v29, v72, v25 row_newbcast:3 row_mask:0xf bank_mask:0xf
    v_and_b32_dpp v30, v72, v26 row_newbcast:3 row_mask:0xf bank_mask:0xf
    v_and_b32_dpp v31, v72, v27 row_newbcast:3 row_mask:0xf bank_mask:0xf
    s_waitcnt vmcnt(7)
    v_mfma_f32_16x16x32_bf16 v[36:39], v[32:35], v[136:139], v[36:39]
    buffer_load_dwordx4 v[92:95], v3, s[12:15], s71 offen offset:0 nt
    s_add_u32 s71, s71, 4096
    v_and_b32_dpp v32, v72, v24 row_newbcast:7 row_mask:0xf bank_mask:0xf
    v_and_b32_dpp v33, v72, v25 row_newbcast:7 row_mask:0xf bank_mask:0xf
    v_and_b32_dpp v34, v72, v26 row_newbcast:7 row_mask:0xf bank_mask:0xf
    v_and_b32_dpp v35, v72, v27 row_newbcast:7 row_mask:0xf bank_mask:0xf
    s_waitcnt vmcnt(6)
    v_mfma_f32_16x16x32_bf16 v[36:39], v[28:31], v[140:143], v[36:39]
    buffer_load_dwordx4 v[96:99], v3, s[12:15], s71 offen offset:0 nt
    s_add_u32 s71, s71, 4096
    buffer_load_dwordx4 a[120:123], v5, s[20:23], s95 offen
    s_add_u32 s95, s95, 4096
    v_and_b32_dpp v28, v72, v24 row_newbcast:11 row_mask:0xf bank_mask:0xf
    v_and_b32_dpp v29, v72, v25 row_newbcast:11 row_mask:0xf bank_mask:0xf
    v_and_b32_dpp v30, v72, v26 row_newbcast:11 row_mask:0xf bank_mask:0xf
    v_and_b32_dpp v31, v72, v27 row_newbcast:11 row_mask:0xf bank_mask:0xf
    s_waitcnt vmcnt(7)
    v_mfma_f32_16x16x32_bf16 v[36:39], v[32:35], v[144:147], v[36:39]
    buffer_load_dwordx4 v[100:103], v3, s[12:15], s71 offen offset:0 nt
    s_add_u32 s71, s71, 4096
    v_and_b32_dpp v32, v72, v24 row_newbcast:15 row_mask:0xf bank_mask:0xf
    v_and_b32_dpp v33, v72, v25 row_newbcast:15 row_mask:0xf bank_mask:0xf
    v_and_b32_dpp v34, v72, v26 row_newbcast:15 row_mask:0xf bank_mask:0xf
    v_and_b32_dpp v35, v72, v27 row_newbcast:15 row_mask:0xf bank_mask:0xf
    s_waitcnt vmcnt(6)
    v_mfma_f32_16x16x32_bf16 v[36:39], v[28:31], v[148:151], v[36:39]
    buffer_load_dwordx4 v[104:107], v3, s[12:15], s71 offen offset:0 nt
    s_add_u32 s71, s71, 4096
    buffer_load_dwordx4 a[124:127], v5, s[20:23], s95 offen
    s_mov_b32 s95, 131072
    v_and_b32_dpp v28, v73, v24 row_newbcast:0 row_mask:0xf bank_mask:0xf
    v_and_b32_dpp v29, v73, v25 row_newbcast:0 row_mask:0xf bank_mask:0xf
    v_and_b32_dpp v30, v73, v26 row_newbcast:0 row_mask:0xf bank_mask:0xf
    v_and_b32_dpp v31, v73, v27 row_newbcast:0 row_mask:0xf bank_mask:0xf
    s_waitcnt vmcnt(7)
    v_mfma_f32_16x16x32_bf16 v[36:39], v[32:35], v[152:155], v[36:39]
    buffer_load_dwordx4 v[108:111], v3, s[12:15], s71 offen offset:0 nt
    s_add_u32 s71, s71, 4096
    v_and_b32_dpp v32, v73, v24 row_newbcast:4 row_mask:0xf bank_mask:0xf
    v_and_b32_dpp v33, v73, v25 row_newbcast:4 row_mask:0xf bank_mask:0xf
    v_and_b32_dpp v34, v73, v26 row_newbcast:4 row_mask:0xf bank_mask:0xf
    v_and_b32_dpp v35, v73, v27 row_newbcast:4 row_mask:0xf bank_mask:0xf
    s_waitcnt vmcnt(6)
    v_mfma_f32_16x16x32_bf16 v[36:39], v[28:31], v[92:95], v[36:39]
    buffer_load_dwordx4 v[112:115], v3, s[12:15], s71 offen offset:0 nt
    s_add_u32 s71, s71, 4096
    v_and_b32_dpp v28, v73, v24 row_newbcast:8 row_mask:0xf bank_mask:0xf
    v_and_b32_dpp v29, v73, v25 row_newbcast:8 row_mask:0xf bank_mask:0xf
    v_and_b32_dpp v30, v73, v26 row_newbcast:8 row_mask:0xf bank_mask:0xf
    v_and_b32_dpp v31, v73, v27 row_newbcast:8 row_mask:0xf bank_mask:0xf
    s_waitcnt vmcnt(6)
    v_mfma_f32_16x16x32_bf16 v[36:39], v[32:35], v[96:99], v[36:39]
    buffer_load_dwordx4 v[116:119], v3, s[12:15], s71 offen offset:0 nt
    s_add_u32 s71, s71, 4096
    v_and_b32_dpp v32, v73, v24 row_newbcast:12 row_mask:0xf bank_mask:0xf
    v_and_b32_dpp v33, v73, v25 row_newbcast:12 row_mask:0xf bank_mask:0xf
    v_and_b32_dpp v34, v73, v26 row_newbcast:12 row_mask:0xf bank_mask:0xf
    v_and_b32_dpp v35, v73, v27 row_newbcast:12 row_mask:0xf bank_mask:0xf
    s_waitcnt vmcnt(5)
    v_mfma_f32_16x16x32_bf16 v[36:39], v[28:31], v[100:103], v[36:39]
    buffer_load_dwordx4 v[120:123], v3, s[12:15], s71 offen offset:0 nt
    s_add_u32 s71, s71, 4096
    v_and_b32_dpp v28, v73, v24 row_newbcast:1 row_mask:0xf bank_mask:0xf
    v_and_b32_dpp v29, v73, v25 row_newbcast:1 row_mask:0xf bank_mask:0xf
    v_and_b32_dpp v30, v73, v26 row_newbcast:1 row_mask:0xf bank_mask:0xf
    v_and_b32_dpp v31, v73, v27 row_newbcast:1 row_mask:0xf bank_mask:0xf
    s_waitcnt vmcnt(5)
    v_mfma_f32_16x16x32_bf16 v[36:39], v[32:35], v[104:107], v[36:39]
    buffer_load_dwordx4 v[124:127], v3, s[12:15], s71 offen offset:0 nt
    s_add_u32 s71, s71, 4096
    v_and_b32_dpp v32, v73, v24 row_newbcast:5 row_mask:0xf bank_mask:0xf
    v_and_b32_dpp v33, v73, v25 row_newbcast:5 row_mask:0xf bank_mask:0xf
    v_and_b32_dpp v34, v73, v26 row_newbcast:5 row_mask:0xf bank_mask:0xf
    v_and_b32_dpp v35, v73, v27 row_newbcast:5 row_mask:0xf bank_mask:0xf
    s_waitcnt vmcnt(4)
    v_mfma_f32_16x16x32_bf16 v[36:39], v[28:31], v[108:111], v[36:39]
    buffer_load_dwordx4 v[128:131], v3, s[12:15], s71 offen offset:0 nt
    s_add_u32 s71, s71, 4096
    v_and_b32_dpp v28, v73, v24 row_newbcast:9 row_mask:0xf bank_mask:0xf
    v_and_b32_dpp v29, v73, v25 row_newbcast:9 row_mask:0xf bank_mask:0xf
    v_and_b32_dpp v30, v73, v26 row_newbcast:9 row_mask:0xf bank_mask:0xf
    v_and_b32_dpp v31, v73, v27 row_newbcast:9 row_mask:0xf bank_mask:0xf
    s_waitcnt vmcnt(4)
    v_mfma_f32_16x16x32_bf16 v[36:39], v[32:35], v[112:115], v[36:39]
    buffer_load_dwordx4 v[132:135], v3, s[12:15], s71 offen offset:0 nt
    s_add_u32 s71, s71, 4096
    v_and_b32_dpp v32, v73, v24 row_newbcast:13 row_mask:0xf bank_mask:0xf
    v_and_b32_dpp v33, v73, v25 row_newbcast:13 row_mask:0xf bank_mask:0xf
    v_and_b32_dpp v34, v73, v26 row_newbcast:13 row_mask:0xf bank_mask:0xf
    v_and_b32_dpp v35, v73, v27 row_newbcast:13 row_mask:0xf bank_mask:0xf
    s_waitcnt vmcnt(4)
    v_mfma_f32_16x16x32_bf16 v[36:39], v[28:31], v[116:119], v[36:39]
    buffer_load_dwordx4 v[136:139], v3, s[12:15], s71 offen offset:0 nt
    s_add_u32 s71, s71, 4096
    v_and_b32_dpp v28, v73, v24 row_newbcast:2 row_mask:0xf bank_mask:0xf
    v_and_b32_dpp v29, v73, v25 row_newbcast:2 row_mask:0xf bank_mask:0xf
    v_and_b32_dpp v30, v73, v26 row_newbcast:2 row_mask:0xf bank_mask:0xf
    v_and_b32_dpp v31, v73, v27 row_newbcast:2 row_mask:0xf bank_mask:0xf
    s_waitcnt vmcnt(4)
    v_mfma_f32_16x16x32_bf16 v[36:39], v[32:35], v[120:123], v[36:39]
    buffer_load_dwordx4 v[140:143], v3, s[12:15], s71 offen offset:0 nt
    s_add_u32 s71, s71, 4096
    v_and_b32_dpp v32, v73, v24 row_newbcast:6 row_mask:0xf bank_mask:0xf
    v_and_b32_dpp v33, v73, v25 row_newbcast:6 row_mask:0xf bank_mask:0xf
    v_and_b32_dpp v34, v73, v26 row_newbcast:6 row_mask:0xf bank_mask:0xf
    v_and_b32_dpp v35, v73, v27 row_newbcast:6 row_mask:0xf bank_mask:0xf
    s_waitcnt vmcnt(4)
    v_mfma_f32_16x16x32_bf16 v[36:39], v[28:31], v[124:127], v[36:39]
    buffer_load_dwordx4 v[144:147], v3, s[12:15], s71 offen offset:0 nt
    s_add_u32 s71, s71, 4096
    v_and_b32_dpp v28, v73, v24 row_newbcast:10 row_mask:0xf bank_mask:0xf
    v_and_b32_dpp v29, v73, v25 row_newbcast:10 row_mask:0xf bank_mask:0xf
    v_and_b32_dpp v30, v73, v26 row_newbcast:10 row_mask:0xf bank_mask:0xf
    v_and_b32_dpp v31, v73, v27 row_newbcast:10 row_mask:0xf bank_mask:0xf
    s_waitcnt vmcnt(4)
    v_mfma_f32_16x16x32_bf16 v[36:39], v[32:35], v[128:131], v[36:39]
    buffer_load_dwordx4 v[148:151], v3, s[12:15], s71 offen offset:0 nt
    s_add_u32 s71, s71, 4096
    v_and_b32_dpp v32, v73, v24 row_newbcast:14 row_mask:0xf bank_mask:0xf
    v_and_b32_dpp v33, v73, v25 row_newbcast:14 row_mask:0xf bank_mask:0xf
    v_and_b32_dpp v34, v73, v26 row_newbcast:14 row_mask:0xf bank_mask:0xf
    v_and_b32_dpp v35, v73, v27 row_newbcast:14 row_mask:0xf bank_mask:0xf
    s_waitcnt vmcnt(4)
    v_mfma_f32_16x16x32_bf16 v[36:39], v[28:31], v[132:135], v[36:39]
    buffer_load_dwordx4 v[152:155], v3, s[12:15], s71 offen offset:0 nt
    s_add_u32 s71, s71, 4096
    v_and_b32_dpp v28, v73, v24 row_newbcast:3 row_mask:0xf bank_mask:0xf
    v_and_b32_dpp v29, v73, v25 row_newbcast:3 row_mask:0xf bank_mask:0xf
    v_and_b32_dpp v30, v73, v26 row_newbcast:3 row_mask:0xf bank_mask:0xf
    v_and_b32_dpp v31, v73, v27 row_newbcast:3 row_mask:0xf bank_mask:0xf
    s_waitcnt vmcnt(4)
    v_mfma_f32_16x16x32_bf16 v[36:39], v[32:35], v[136:139], v[36:39]
    buffer_load_dwordx4 v[92:95], v3, s[12:15], s71 offen offset:0 nt
    s_add_u32 s71, s71, 4096
    v_and_b32_dpp v32, v73, v24 row_newbcast:7 row_mask:0xf bank_mask:0xf
    v_and_b32_dpp v33, v73, v25 row_newbcast:7 row_mask:0xf bank_mask:0xf
    v_and_b32_dpp v34, v73, v26 row_newbcast:7 row_mask:0xf bank_mask:0xf
    v_and_b32_dpp v35, v73, v27 row_newbcast:7 row_mask:0xf bank_mask:0xf
    s_waitcnt vmcnt(4)
    v_mfma_f32_16x16x32_bf16 v[36:39], v[28:31], v[140:143], v[36:39]
    buffer_load_dwordx4 v[96:99], v3, s[12:15], s71 offen offset:0 nt
    s_add_u32 s71, s71, 4096
    v_and_b32_dpp v28, v73, v24 row_newbcast:11 row_mask:0xf bank_mask:0xf
    v_and_b32_dpp v29, v73, v25 row_newbcast:11 row_mask:0xf bank_mask:0xf
    v_and_b32_dpp v30, v73, v26 row_newbcast:11 row_mask:0xf bank_mask:0xf
    v_and_b32_dpp v31, v73, v27 row_newbcast:11 row_mask:0xf bank_mask:0xf
    s_waitcnt vmcnt(4)
    v_mfma_f32_16x16x32_bf16 v[36:39], v[32:35], v[144:147], v[36:39]
    buffer_load_dwordx4 v[100:103], v3, s[12:15], s71 offen offset:0 nt
    s_add_u32 s71, s71, 4096
    v_and_b32_dpp v32, v73, v24 row_newbcast:15 row_mask:0xf bank_mask:0xf
    v_and_b32_dpp v33, v73, v25 row_newbcast:15 row_mask:0xf bank_mask:0xf
    v_and_b32_dpp v34, v73, v26 row_newbcast:15 row_mask:0xf bank_mask:0xf
    v_and_b32_dpp v35, v73, v27 row_newbcast:15 row_mask:0xf bank_mask:0xf
    s_waitcnt vmcnt(4)
    v_mfma_f32_16x16x32_bf16 v[36:39], v[28:31], v[148:151], v[36:39]
    buffer_load_dwordx4 v[104:107], v3, s[12:15], s71 offen offset:0 nt
    s_add_u32 s71, s71, 4096
    v_and_b32_dpp v28, v74, v24 row_newbcast:0 row_mask:0xf bank_mask:0xf
    v_and_b32_dpp v29, v74, v25 row_newbcast:0 row_mask:0xf bank_mask:0xf
    v_and_b32_dpp v30, v74, v26 row_newbcast:0 row_mask:0xf bank_mask:0xf
    v_and_b32_dpp v31, v74, v27 row_newbcast:0 row_mask:0xf bank_mask:0xf
    s_waitcnt vmcnt(4)
    v_mfma_f32_16x16x32_bf16 v[36:39], v[32:35], v[152:155], v[36:39]
    buffer_load_dwordx4 v[108:111], v3, s[12:15], s71 offen offset:0 nt
    s_add_u32 s71, s71, 4096
    s_mov_b32 s73, 0
    .p2align 3
L_vloop:
    v_and_b32_dpp v32, v74, v24 row_newbcast:4 row_mask:0xf bank_mask:0xf
    v_and_b32_dpp v33, v74, v25 row_newbcast:4 row_mask:0xf bank_mask:0xf
    v_and_b32_dpp v34, v74, v26 row_newbcast:4 row_mask:0xf bank_mask:0xf
    v_and_b32_dpp v35, v74, v27 row_newbcast:4 row_mask:0xf bank_mask:0xf
    s_waitcnt vmcnt(4)
    v_mfma_f32_16x16x32_bf16 v[36:39], v[28:31], v[92:95], v[36:39]
    buffer_load_dwordx4 v[112:115], v3, s[12:15], s71 offen offset:0 nt
    s_add_u32 s71, s71, 4096
    v_and_b32_dpp v28, v74, v24 row_newbcast:8 row_mask:0xf bank_mask:0xf
    v_and_b32_dpp v29, v74, v25 row_newbcast:8 row_mask:0xf bank_mask:0xf
    v_and_b32_dpp v30, v74, v26 row_newbcast:8 row_mask:0xf bank_mask:0xf
    v_and_b32_dpp v31, v74, v27 row_newbcast:8 row_mask:0xf bank_mask:0xf
    s_waitcnt vmcnt(4)
    v_mfma_f32_16x16x32_bf16 v[36:39], v[32:35], v[96:99], v[36:39]
    buffer_load_dwordx4 v[116:119], v3, s[12:15], s71 offen offset:0 nt
    s_add_u32 s71, s71, 4096
    v_and_b32_dpp v32, v74, v24 row_newbcast:12 row_mask:0xf bank_mask:0xf
    v_and_b32_dpp v33, v74, v25 row_newbcast:12 row_mask:0xf bank_mask:0xf
    v_and_b32_dpp v34, v74, v26 row_newbcast:12 row_mask:0xf bank_mask:0xf
    v_and_b32_dpp v35, v74, v27 row_newbcast:12 row_mask:0xf bank_mask:0xf
    s_waitcnt vmcnt(4)
    v_mfma_f32_16x16x32_bf16 v[36:39], v[28:31], v[100:103], v[36:39]
    buffer_load_dwordx4 v[120:123], v3, s[12:15], s71 offen offset:0 nt
    s_add_u32 s71, s71, 4096
    v_and_b32_dpp v28, v74, v24 row_newbcast:1 row_mask:0xf bank_mask:0xf
    v_and_b32_dpp v29, v74, v25 row_newbcast:1 row_mask:0xf bank_mask:0xf
    v_and_b32_dpp v30, v74, v26 row_newbcast:1 row_mask:0xf bank_mask:0xf
    v_and_b32_dpp v31, v74, v27 row_newbcast:1 row_mask:0xf bank_mask:0xf
    s_waitcnt vmcnt(4)
    v_mfma_f32_16x16x32_bf16 v[36:39], v[32:35], v[104:107], v[36:39]
    buffer_load_dwordx4 v[124:127], v3, s[12:15], s71 offen offset:0 nt
    s_add_u32 s71, s71, 4096
    v_and_b32_dpp v32, v74, v24 row_newbcast:5 row_mask:0xf bank_mask:0xf
    v_and_b32_dpp v33, v74, v25 row_newbcast:5 row_mask:0xf bank_mask:0xf
    v_and_b32_dpp v34, v74, v26 row_newbcast:5 row_mask:0xf bank_mask:0xf
    v_and_b32_dpp v35, v74, v27 row_newbcast:5 row_mask:0xf bank_mask:0xf
    s_waitcnt vmcnt(4)
    v_mfma_f32_16x16x32_bf16 v[36:39], v[28:31], v[108:111], v[36:39]
    buffer_load_dwordx4 v[128:131], v3, s[12:15], s71 offen offset:0 nt
    s_add_u32 s71, s71, 4096
    v_and_b32_dpp v28, v74, v24 row_newbcast:9 row_mask:0xf bank_mask:0xf
    v_and_b32_dpp v29, v74, v25 row_newbcast:9 row_mask:0xf bank_mask:0xf
    v_and_b32_dpp v30, v74, v26 row_newbcast:9 row_mask:0xf bank_mask:0xf
    v_and_b32_dpp v31, v74, v27 row_newbcast:9 row_mask:0xf bank_mask:0xf
    s_waitcnt vmcnt(4)
    v_mfma_f32_16x16x32_bf16 v[36:39], v[32:35], v[112:115], v[36:39]
    buffer_load_dwordx4 v[132:135], v3, s[12:15], s71 offen offset:0 nt
    s_add_u32 s71, s71, 4096
    v_and_b32_dpp v32, v74, v24 row_newbcast:13 row_mask:0xf bank_mask:0xf
    v_and_b32_dpp v33, v74, v25 row_newbcast:13 row_mask:0xf bank_mask:0xf
    v_and_b32_dpp v34, v74, v26 row_newbcast:13 row_mask:0xf bank_mask:0xf
    v_and_b32_dpp v35, v74, v27 row_newbcast:13 row_mask:0xf bank_mask:0xf
    s_waitcnt vmcnt(4)
    v_mfma_f32_16x16x32_bf16 v[36:39], v[28:31], v[116:119], v[36:39]
    buffer_load_dwordx4 v[136:139], v3, s[12:15], s71 offen offset:0 nt
    s_add_u32 s71, s71, 4096
    v_and_b32_dpp v28, v74, v24 row_newbcast:2 row_mask:0xf bank_mask:0xf
    v_and_b32_dpp v29, v74, v25 row_newbcast:2 row_mask:0xf bank_mask:0xf
    v_and_b32_dpp v30, v74, v26 row_newbcast:2 row_mask:0xf bank_mask:0xf
    v_and_b32_dpp v31, v74, v27 row_newbcast:2 row_mask:0xf bank_mask:0xf
    s_waitcnt vmcnt(4)
    v_mfma_f32_16x16x32_bf16 v[36:39], v[32:35], v[120:123], v[36:39]
    buffer_load_dwordx4 v[140:143], v3, s[12:15], s71 offen offset:0 nt
    s_add_u32 s71, s71, 4096
    v_and_b32_dpp v32, v74, v24 row_newbcast:6 row_mask:0xf bank_mask:0xf
    v_and_b32_dpp v33, v74, v25 row_newbcast:6 row_mask:0xf bank_mask:0xf
    v_and_b32_dpp v34, v74, v26 row_newbcast:6 row_mask:0xf bank_mask:0xf
    v_and_b32_dpp v35, v74, v27 row_newbcast:6 row_mask:0xf bank_mask:0xf
    s_waitcnt vmcnt(4)
    v_mfma_f32_16x16x32_bf16 v[36:39], v[28:31], v[124:127], v[36:39]
    buffer_load_dwordx4 v[144:147], v3, s[12:15], s71 offen offset:0 nt
    s_add_u32 s71, s71, 4096
    v_and_b32_dpp v28, v74, v24 row_newbcast:10 row_mask:0xf bank_mask:0xf
    v_and_b32_dpp v29, v74, v25 row_newbcast:10 row_mask:0xf bank_mask:0xf
    v_and_b32_dpp v30, v74, v26 row_newbcast:10 row_mask:0xf bank_mask:0xf
    v_and_b32_dpp v31, v74, v27 row_newbcast:10 row_mask:0xf bank_mask:0xf
    s_waitcnt vmcnt(4)
    v_mfma_f32_16x16x32_bf16 v[36:39], v[32:35], v[128:131], v[36:39]
    buffer_load_dwordx4 v[148:151], v3, s[12:15], s71 offen offset:0 nt
    s_add_u32 s71, s71, 4096
    v_and_b32_dpp v32, v74, v24 row_newbcast:14 row_mask:0xf bank_mask:0xf
    v_and_b32_dpp v33, v74, v25 row_newbcast:14 row_mask:0xf bank_mask:0xf
    v_and_b32_dpp v34, v74, v26 row_newbcast:14 row_mask:0xf bank_mask:0xf
    v_and_b32_dpp v35, v74, v27 row_newbcast:14 row_mask:0xf bank_mask:0xf
    s_waitcnt vmcnt(4)
    v_mfma_f32_16x16x32_bf16 v[36:39], v[28:31], v[132:135], v[36:39]
    buffer_load_dwordx4 v[152:155], v3, s[12:15], s71 offen offset:0 nt
    s_add_u32 s71, s71, 4096
    v_and_b32_dpp v28, v74, v24 row_newbcast:3 row_mask:0xf bank_mask:0xf
    v_and_b32_dpp v29, v74, v25 row_newbcast:3 row_mask:0xf bank_mask:0xf
    v_and_b32_dpp v30, v74, v26 row_newbcast:3 row_mask:0xf bank_mask:0xf
    v_and_b32_dpp v31, v74, v27 row_newbcast:3 row_mask:0xf bank_mask:0xf
    s_waitcnt vmcnt(4)
    v_mfma_f32_16x16x32_bf16 v[36:39], v[32:35], v[136:139], v[36:39]
    buffer_load_dwordx4 v[92:95], v3, s[12:15], s71 offen offset:0 nt
    s_add_u32 s71, s71, 4096
    v_and_b32_dpp v32, v74, v24 row_newbcast:7 row_mask:0xf bank_mask:0xf
    v_and_b32_dpp v33, v74, v25 row_newbcast:7 row_mask:0xf bank_mask:0xf
    v_and_b32_dpp v34, v74, v26 row_newbcast:7 row_mask:0xf bank_mask:0xf
    v_and_b32_dpp v35, v74, v27 row_newbcast:7 row_mask:0xf bank_mask:0xf
    s_waitcnt vmcnt(4)
    v_mfma_f32_16x16x32_bf16 v[36:39], v[28:31], v[140:143], v[36:39]
    buffer_load_dwordx4 v[96:99], v3, s[12:15], s71 offen offset:0 nt
    s_add_u32 s71, s71, 4096
    v_and_b32_dpp v28, v74, v24 row_newbcast:11 row_mask:0xf bank_mask:0xf
    v_and_b32_dpp v29, v74, v25 row_newbcast:11 row_mask:0xf bank_mask:0xf
    v_and_b32_dpp v30, v74, v26 row_newbcast:11 row_mask:0xf bank_mask:0xf
    v_and_b32_dpp v31, v74, v27 row_newbcast:11 row_mask:0xf bank_mask:0xf
    s_waitcnt vmcnt(4)
    v_mfma_f32_16x16x32_bf16 v[36:39], v[32:35], v[144:147], v[36:39]
    buffer_load_dwordx4 v[100:103], v3, s[12:15], s71 offen offset:0 nt
    s_add_u32 s71, s71, 4096
    v_and_b32_dpp v32, v74, v24 row_newbcast:15 row_mask:0xf bank_mask:0xf
    v_and_b32_dpp v33, v74, v25 row_newbcast:15 row_mask:0xf bank_mask:0xf
    v_and_b32_dpp v34, v74, v26 row_newbcast:15 row_mask:0xf bank_mask:0xf
    v_and_b32_dpp v35, v74, v27 row_newbcast:15 row_mask:0xf bank_mask:0xf
    s_waitcnt vmcnt(4)
    v_mfma_f32_16x16x32_bf16 v[36:39], v[28:31], v[148:151], v[36:39]
    buffer_load_dwordx4 v[104:107], v3, s[12:15], s71 offen offset:0 nt
    s_add_u32 s71, s71, 4096
    v_and_b32_dpp v28, v75, v24 row_newbcast:0 row_mask:0xf bank_mask:0xf
    v_and_b32_dpp v29, v75, v25 row_newbcast:0 row_mask:0xf bank_mask:0xf
    v_and_b32_dpp v30, v75, v26 row_newbcast:0 row_mask:0xf bank_mask:0xf
    v_and_b32_dpp v31, v75, v27 row_newbcast:0 row_mask:0xf bank_mask:0xf
    s_waitcnt vmcnt(4)
    v_mfma_f32_16x16x32_bf16 v[36:39], v[32:35], v[152:155], v[36:39]
    buffer_load_dwordx4 v[108:111], v3, s[12:15], s71 offen offset:0 nt
    s_add_u32 s71, s71, 4096
    v_mov_b32 v74, v75
    v_mov_b32 v75, v76
    v_mov_b32 v76, v77
    v_mov_b32 v77, v78
    v_mov_b32 v78, v79
    v_mov_b32 v79, v80
    v_mov_b32 v80, v81
    v_mov_b32 v81, v82
    v_mov_b32 v82, v83
    v_mov_b32 v83, v84
    v_mov_b32 v84, v85
    v_mov_b32 v85, v86
    v_mov_b32 v86, v87
    s_add_u32 s73, s73, 1
    s_cmp_lt_u32 s73, 13
    s_cbranch_scc1 L_vloop
    s_waitcnt lgkmcnt(0)
    s_barrier
    ds_read_b128 v[56:59], v13 offset:3072
    ds_read_b128 v[60:63], v13 offset:3088
    ds_read_b32 v15, v13 offset:3104
    s_waitcnt lgkmcnt(0)
    v_readfirstlane_b32 s85, v15
    v_max3_f32 v64, v56, v57, v58
    v_max_f32 v64, v64, v59
    v_sub_f32 v56, v56, v64
    v_sub_f32 v57, v57, v64
    v_sub_f32 v58, v58, v64
    v_sub_f32 v59, v59, v64
    v_sub_f32 v14, v14, v64
    v_exp_f32 v56, v56
    v_exp_f32 v57, v57
    v_exp_f32 v58, v58
    v_exp_f32 v59, v59
    v_exp_f32 v14, v14
    s_and_b32 s85, s85, 0xff
    v_mul_f32 v60, v60, v56
    v_fmac_f32 v60, v61, v57
    v_fmac_f32 v60, v62, v58
    v_fmac_f32 v60, v63, v59
    v_rcp_f32 v60, v60
    s_nop 0
    v_mul_f32 v14, v14, v60
    v_and_b32_dpp v32, v74, v24 row_newbcast:4 row_mask:0xf bank_mask:0xf
    v_and_b32_dpp v33, v74, v25 row_newbcast:4 row_mask:0xf bank_mask:0xf
    v_and_b32_dpp v34, v74, v26 row_newbcast:4 row_mask:0xf bank_mask:0xf
    v_and_b32_dpp v35, v74, v27 row_newbcast:4 row_mask:0xf bank_mask:0xf
    s_waitcnt vmcnt(4)
    v_mfma_f32_16x16x32_bf16 v[36:39], v[28:31], v[92:95], v[36:39]
    buffer_load_dwordx4 v[112:115], v3, s[12:15], s71 offen offset:0 nt
    s_add_u32 s71, s71, 4096
    buffer_load_dwordx4 v[116:119], v3, s[12:15], s71 offen offset:0 nt
    s_add_u32 s71, s71, 4096
    buffer_load_dwordx4 v[120:123], v3, s[12:15], s71 offen offset:0 nt
    s_add_u32 s71, s71, 4096
    v_and_b32_dpp v28, v74, v24 row_newbcast:8 row_mask:0xf bank_mask:0xf
    v_and_b32_dpp v29, v74, v25 row_newbcast:8 row_mask:0xf bank_mask:0xf
    v_and_b32_dpp v30, v74, v26 row_newbcast:8 row_mask:0xf bank_mask:0xf
    v_and_b32_dpp v31, v74, v27 row_newbcast:8 row_mask:0xf bank_mask:0xf
    s_waitcnt vmcnt(6)
    v_mfma_f32_16x16x32_bf16 v[36:39], v[32:35], v[96:99], v[36:39]
    buffer_load_dwordx4 v[124:127], v3, s[12:15], s71 offen offset:0 nt
    s_add_u32 s71, s71, 4096
    v_and_b32_dpp v32, v74, v24 row_newbcast:12 row_mask:0xf bank_mask:0xf
    v_and_b32_dpp v33, v74, v25 row_newbcast:12 row_mask:0xf bank_mask:0xf
    v_and_b32_dpp v34, v74, v26 row_newbcast:12 row_mask:0xf bank_mask:0xf
    v_and_b32_dpp v35, v74, v27 row_newbcast:12 row_mask:0xf bank_mask:0xf
    s_waitcnt vmcnt(6)
    v_mfma_f32_16x16x32_bf16 v[36:39], v[28:31], v[100:103], v[36:39]
    buffer_load_dwordx4 v[128:131], v3, s[12:15], s71 offen offset:0 nt
    s_add_u32 s71, s71, 4096
    v_and_b32_dpp v28, v74, v24 row_newbcast:1 row_mask:0xf bank_mask:0xf
    v_and_b32_dpp v29, v74, v25 row_newbcast:1 row_mask:0xf bank_mask:0xf
    v_and_b32_dpp v30, v74, v26 row_newbcast:1 row_mask:0xf bank_mask:0xf
    v_and_b32_dpp v31, v74, v27 row_newbcast:1 row_mask:0xf bank_mask:0xf
    s_waitcnt vmcnt(6)
    v_mfma_f32_16x16x32_bf16 v[36:39], v[32:35], v[104:107], v[36:39]
    buffer_load_dwordx4 v[132:135], v3, s[12:15], s71 offen offset:0 nt
    s_add_u32 s71, s71, 4096
    v_and_b32_dpp v32, v74, v24 row_newbcast:5 row_mask:0xf bank_mask:0xf
    v_and_b32_dpp v33, v74, v25 row_newbcast:5 row_mask:0xf bank_mask:0xf
    v_and_b32_dpp v34, v74, v26 row_newbcast:5 row_mask:0xf bank_mask:0xf
    v_and_b32_dpp v35, v74, v27 row_newbcast:5 row_mask:0xf bank_mask:0xf
    s_waitcnt vmcnt(6)
    v_mfma_f32_16x16x32_bf16 v[36:39], v[28:31], v[108:111], v[36:39]
    buffer_load_dwordx4 v[136:139], v3, s[12:15], s71 offen offset:0 nt
    s_add_u32 s71, s71, 4096
    v_and_b32_dpp v28, v74, v24 row_newbcast:9 row_mask:0xf bank_mask:0xf
    v_and_b32_dpp v29, v74, v25 row_newbcast:9 row_mask:0xf bank_mask:0xf
    v_and_b32_dpp v30, v74, v26 row_newbcast:9 row_mask:0xf bank_mask:0xf
    v_and_b32_dpp v31, v74, v27 row_newbcast:9 row_mask:0xf bank_mask:0xf
    s_waitcnt vmcnt(6)
    v_mfma_f32_16x16x32_bf16 v[36:39], v[32:35], v[112:115], v[36:39]
    buffer_load_dwordx4 v[140:143], v3, s[12:15], s71 offen offset:0 nt
    s_add_u32 s71, s71, 4096
    v_and_b32_dpp v32, v74, v24 row_newbcast:13 row_mask:0xf bank_mask:0xf
    v_and_b32_dpp v33, v74, v25 row_newbcast:13 row_mask:0xf bank_mask:0xf
    v_and_b32_dpp v34, v74, v26 row_newbcast:13 row_mask:0xf bank_mask:0xf
    v_and_b32_dpp v35, v74, v27 row_newbcast:13 row_mask:0xf bank_mask:0xf
    s_waitcnt vmcnt(6)
    v_mfma_f32_16x16x32_bf16 v[36:39], v[28:31], v[116:119], v[36:39]
    buffer_load_dwordx4 v[144:147], v3, s[12:15], s71 offen offset:0 nt
    s_add_u32 s71, s71, 4096
    v_and_b32_dpp v28, v74, v24 row_newbcast:2 row_mask:0xf bank_mask:0xf
    v_and_b32_dpp v29, v74, v25 row_newbcast:2 row_mask:0xf bank_mask:0xf
    v_and_b32_dpp v30, v74, v26 row_newbcast:2 row_mask:0xf bank_mask:0xf
    v_and_b32_dpp v31, v74, v27 row_newbcast:2 row_mask:0xf bank_mask:0xf
    s_waitcnt vmcnt(6)
    v_mfma_f32_16x16x32_bf16 v[36:39], v[32:35], v[120:123], v[36:39]
    buffer_load_dwordx4 v[148:151], v3, s[12:15], s71 offen offset:0 nt
    s_add_u32 s71, s71, 4096
    v_and_b32_dpp v32, v74, v24 row_newbcast:6 row_mask:0xf bank_mask:0xf
    v_and_b32_dpp v33, v74, v25 row_newbcast:6 row_mask:0xf bank_mask:0xf
    v_and_b32_dpp v34, v74, v26 row_newbcast:6 row_mask:0xf bank_mask:0xf
    v_and_b32_dpp v35, v74, v27 row_newbcast:6 row_mask:0xf bank_mask:0xf
    s_waitcnt vmcnt(6)
    v_mfma_f32_16x16x32_bf16 v[36:39], v[28:31], v[124:127], v[36:39]
    buffer_load_dwordx4 v[152:155], v3, s[12:15], s71 offen offset:0 nt
    s_add_u32 s71, s71, 4096
    v_and_b32_dpp v28, v74, v24 row_newbcast:10 row_mask:0xf bank_mask:0xf
    v_and_b32_dpp v29, v74, v25 row_newbcast:10 row_mask:0xf bank_mask:0xf
    v_and_b32_dpp v30, v74, v26 row_newbcast:10 row_mask:0xf bank_mask:0xf
    v_and_b32_dpp v31, v74, v27 row_newbcast:10 row_mask:0xf bank_mask:0xf
    s_waitcnt vmcnt(6)
    v_mfma_f32_16x16x32_bf16 v[36:39], v[32:35], v[128:131], v[36:39]
    v_and_b32_dpp v32, v74, v24 row_newbcast:14 row_mask:0xf bank_mask:0xf
    v_and_b32_dpp v33, v74, v25 row_newbcast:14 row_mask:0xf bank_mask:0xf
    v_and_b32_dpp v34, v74, v26 row_newbcast:14 row_mask:0xf bank_mask:0xf
    v_and_b32_dpp v35, v74, v27 row_newbcast:14 row_mask:0xf bank_mask:0xf
    s_waitcnt vmcnt(5)
    v_mfma_f32_16x16x32_bf16 v[36:39], v[28:31], v[132:135], v[36:39]
    v_and_b32_dpp v28, v74, v24 row_newbcast:3 row_mask:0xf bank_mask:0xf
    v_and_b32_dpp v29, v74, v25 row_newbcast:3 row_mask:0xf bank_mask:0xf
    v_and_b32_dpp v30, v74, v26 row_newbcast:3 row_mask:0xf bank_mask:0xf
    v_and_b32_dpp v31, v74, v27 row_newbcast:3 row_mask:0xf bank_mask:0xf
    s_waitcnt vmcnt(4)
    v_mfma_f32_16x16x32_bf16 v[36:39], v[32:35], v[136:139], v[36:39]
    v_and_b32_dpp v32, v74, v24 row_newbcast:7 row_mask:0xf bank_mask:0xf
    v_and_b32_dpp v33, v74, v25 row_newbcast:7 row_mask:0xf bank_mask:0xf
    v_and_b32_dpp v34, v74, v26 row_newbcast:7 row_mask:0xf bank_mask:0xf
    v_and_b32_dpp v35, v74, v27 row_newbcast:7 row_mask:0xf bank_mask:0xf
    s_waitcnt vmcnt(3)
    v_mfma_f32_16x16x32_bf16 v[36:39], v[28:31], v[140:143], v[36:39]
    v_and_b32_dpp v28, v74, v24 row_newbcast:11 row_mask:0xf bank_mask:0xf
    v_and_b32_dpp v29, v74, v25 row_newbcast:11 row_mask:0xf bank_mask:0xf
    v_and_b32_dpp v30, v74, v26 row_newbcast:11 row_mask:0xf bank_mask:0xf
    v_and_b32_dpp v31, v74, v27 row_newbcast:11 row_mask:0xf bank_mask:0xf
    s_waitcnt vmcnt(2)
    v_mfma_f32_16x16x32_bf16 v[36:39], v[32:35], v[144:147], v[36:39]
    v_and_b32_dpp v32, v74, v24 row_newbcast:15 row_mask:0xf bank_mask:0xf
    v_and_b32_dpp v33, v74, v25 row_newbcast:15 row_mask:0xf bank_mask:0xf
    v_and_b32_dpp v34, v74, v26 row_newbcast:15 row_mask:0xf bank_mask:0xf
    v_and_b32_dpp v35, v74, v27 row_newbcast:15 row_mask:0xf bank_mask:0xf
    s_waitcnt vmcnt(1)
    v_mfma_f32_16x16x32_bf16 v[36:39], v[28:31], v[148:151], v[36:39]
    s_waitcnt vmcnt(0)
    s_nop 0
    v_mfma_f32_16x16x32_bf16 v[36:39], v[32:35], v[152:155], v[36:39]
    s_nop 7
    v_mul_f32 v36, v36, v14
    v_mul_f32 v37, v37, v14
    v_mul_f32 v38, v38, v14
    v_mul_f32 v39, v39, v14
    s_mov_b32 exec_hi, 0
    ds_write_b128 v9, v[36:39] offset:4096
    s_mov_b32 exec_hi, -1
    s_waitcnt lgkmcnt(0)
    s_barrier
    ds_read2st64_b32 v[56:57], v10 offset0:16 offset1:18
    ds_read2st64_b32 v[58:59], v10 offset0:20 offset1:22
    ds_read2st64_b32 v[60:61], v11 offset0:16 offset1:18
    ds_read2st64_b32 v[62:63], v11 offset0:20 offset1:22
    s_waitcnt lgkmcnt(2)
    v_add_f32 v56, v56, v57
    v_add_f32 v58, v58, v59
    v_add_f32 v56, v56, v58
    v_cvt_pk_bf16_f32 v18, v56, v56
    s_waitcnt lgkmcnt(0)
    v_add_f32 v60, v60, v61
    v_add_f32 v62, v62, v63
    v_and_b32_dpp v28, v18, v24 row_newbcast:0 row_mask:0xf bank_mask:0xf
    v_and_b32_dpp v29, v18, v25 row_newbcast:0 row_mask:0xf bank_mask:0xf
    v_and_b32_dpp v30, v18, v26 row_newbcast:0 row_mask:0xf bank_mask:0xf
    v_and_b32_dpp v31, v18, v27 row_newbcast:0 row_mask:0xf bank_mask:0xf
    v_add_f32 v60, v60, v62
    v_cvt_pk_bf16_f32 v19, v60, v60
    v_and_b32_dpp v32, v18, v24 row_newbcast:1 row_mask:0xf bank_mask:0xf
    v_and_b32_dpp v33, v18, v25 row_newbcast:1 row_mask:0xf bank_mask:0xf
    v_and_b32_dpp v34, v18, v26 row_newbcast:1 row_mask:0xf bank_mask:0xf
    v_and_b32_dpp v35, v18, v27 row_newbcast:1 row_mask:0xf bank_mask:0xf
    v_mfma_f32_16x16x32_bf16 v[36:39], v[28:31], a[0:3], 0
    v_and_b32_dpp v28, v18, v24 row_newbcast:2 row_mask:0xf bank_mask:0xf
    v_and_b32_dpp v29, v18, v25 row_newbcast:2 row_mask:0xf bank_mask:0xf
    v_and_b32_dpp v30, v18, v26 row_newbcast:2 row_mask:0xf bank_mask:0xf
    v_and_b32_dpp v31, v18, v27 row_newbcast:2 row_mask:0xf bank_mask:0xf
    v_mfma_f32_16x16x32_bf16 v[36:39], v[32:35], a[4:7], v[36:39]
    v_and_b32_dpp v32, v18, v24 row_newbcast:3 row_mask:0xf bank_mask:0xf
    v_and_b32_dpp v33, v18, v25 row_newbcast:3 row_mask:0xf bank_mask:0xf
    v_and_b32_dpp v34, v18, v26 row_newbcast:3 row_mask:0xf bank_mask:0xf
    v_and_b32_dpp v35, v18, v27 row_newbcast:3 row_mask:0xf bank_mask:0xf
    v_mfma_f32_16x16x32_bf16 v[36:39], v[28:31], a[8:11], v[36:39]
    v_and_b32_dpp v28, v18, v24 row_newbcast:4 row_mask:0xf bank_mask:0xf
    v_and_b32_dpp v29, v18, v25 row_newbcast:4 row_mask:0xf bank_mask:0xf
    v_and_b32_dpp v30, v18, v26 row_newbcast:4 row_mask:0xf bank_mask:0xf
    v_and_b32_dpp v31, v18, v27 row_newbcast:4 row_mask:0xf bank_mask:0xf
    v_mfma_f32_16x16x32_bf16 v[36:39], v[32:35], a[12:15], v[36:39]
    v_and_b32_dpp v32, v18, v24 row_newbcast:5 row_mask:0xf bank_mask:0xf
    v_and_b32_dpp v33, v18, v25 row_newbcast:5 row_mask:0xf bank_mask:0xf
    v_and_b32_dpp v34, v18, v26 row_newbcast:5 row_mask:0xf bank_mask:0xf
    v_and_b32_dpp v35, v18, v27 row_newbcast:5 row_mask:0xf bank_mask:0xf
    v_mfma_f32_16x16x32_bf16 v[36:39], v[28:31], a[16:19], v[36:39]
    v_and_b32_dpp v28, v18, v24 row_newbcast:6 row_mask:0xf bank_mask:0xf
    v_and_b32_dpp v29, v18, v25 row_newbcast:6 row_mask:0xf bank_mask:0xf
    v_and_b32_dpp v30, v18, v26 row_newbcast:6 row_mask:0xf bank_mask:0xf
    v_and_b32_dpp v31, v18, v27 row_newbcast:6 row_mask:0xf bank_mask:0xf
    v_mfma_f32_16x16x32_bf16 v[36:39], v[32:35], a[20:23], v[36:39]
    v_and_b32_dpp v32, v18, v24 row_newbcast:7 row_mask:0xf bank_mask:0xf
    v_and_b32_dpp v33, v18, v25 row_newbcast:7 row_mask:0xf bank_mask:0xf
    v_and_b32_dpp v34, v18, v26 row_newbcast:7 row_mask:0xf bank_mask:0xf
    v_and_b32_dpp v35, v18, v27 row_newbcast:7 row_mask:0xf bank_mask:0xf
    v_mfma_f32_16x16x32_bf16 v[36:39], v[28:31], a[24:27], v[36:39]
    v_and_b32_dpp v28, v18, v24 row_newbcast:8 row_mask:0xf bank_mask:0xf
    v_and_b32_dpp v29, v18, v25 row_newbcast:8 row_mask:0xf bank_mask:0xf
    v_and_b32_dpp v30, v18, v26 row_newbcast:8 row_mask:0xf bank_mask:0xf
    v_and_b32_dpp v31, v18, v27 row_newbcast:8 row_mask:0xf bank_mask:0xf
    v_mfma_f32_16x16x32_bf16 v[36:39], v[32:35], a[28:31], v[36:39]
    v_and_b32_dpp v32, v18, v24 row_newbcast:9 row_mask:0xf bank_mask:0xf
    v_and_b32_dpp v33, v18, v25 row_newbcast:9 row_mask:0xf bank_mask:0xf
    v_and_b32_dpp v34, v18, v26 row_newbcast:9 row_mask:0xf bank_mask:0xf
    v_and_b32_dpp v35, v18, v27 row_newbcast:9 row_mask:0xf bank_mask:0xf
    v_mfma_f32_16x16x32_bf16 v[36:39], v[28:31], a[32:35], v[36:39]
    v_and_b32_dpp v28, v18, v24 row_newbcast:10 row_mask:0xf bank_mask:0xf
    v_and_b32_dpp v29, v18, v25 row_newbcast:10 row_mask:0xf bank_mask:0xf
    v_and_b32_dpp v30, v18, v26 row_newbcast:10 row_mask:0xf bank_mask:0xf
    v_and_b32_dpp v31, v18, v27 row_newbcast:10 row_mask:0xf bank_mask:0xf
    v_mfma_f32_16x16x32_bf16 v[36:39], v[32:35], a[36:39], v[36:39]
    v_and_b32_dpp v32, v18, v24 row_newbcast:11 row_mask:0xf bank_mask:0xf
    v_and_b32_dpp v33, v18, v25 row_newbcast:11 row_mask:0xf bank_mask:0xf
    v_and_b32_dpp v34, v18, v26 row_newbcast:11 row_mask:0xf bank_mask:0xf
    v_and_b32_dpp v35, v18, v27 row_newbcast:11 row_mask:0xf bank_mask:0xf
    v_mfma_f32_16x16x32_bf16 v[36:39], v[28:31], a[40:43], v[36:39]
    v_and_b32_dpp v28, v18, v24 row_newbcast:12 row_mask:0xf bank_mask:0xf
    v_and_b32_dpp v29, v18, v25 row_newbcast:12 row_mask:0xf bank_mask:0xf
    v_and_b32_dpp v30, v18, v26 row_newbcast:12 row_mask:0xf bank_mask:0xf
    v_and_b32_dpp v31, v18, v27 row_newbcast:12 row_mask:0xf bank_mask:0xf
    v_mfma_f32_16x16x32_bf16 v[36:39], v[32:35], a[44:47], v[36:39]
    v_and_b32_dpp v32, v18, v24 row_newbcast:13 row_mask:0xf bank_mask:0xf
    v_and_b32_dpp v33, v18, v25 row_newbcast:13 row_mask:0xf bank_mask:0xf
    v_and_b32_dpp v34, v18, v26 row_newbcast:13 row_mask:0xf bank_mask:0xf
    v_and_b32_dpp v35, v18, v27 row_newbcast:13 row_mask:0xf bank_mask:0xf
    v_mfma_f32_16x16x32_bf16 v[36:39], v[28:31], a[48:51], v[36:39]
    v_and_b32_dpp v28, v18, v24 row_newbcast:14 row_mask:0xf bank_mask:0xf
    v_and_b32_dpp v29, v18, v25 row_newbcast:14 row_mask:0xf bank_mask:0xf
    v_and_b32_dpp v30, v18, v26 row_newbcast:14 row_mask:0xf bank_mask:0xf
    v_and_b32_dpp v31, v18, v27 row_newbcast:14 row_mask:0xf bank_mask:0xf
    v_mfma_f32_16x16x32_bf16 v[36:39], v[32:35], a[52:55], v[36:39]
    v_and_b32_dpp v32, v18, v24 row_newbcast:15 row_mask:0xf bank_mask:0xf
    v_and_b32_dpp v33, v18, v25 row_newbcast:15 row_mask:0xf bank_mask:0xf
    v_and_b32_dpp v34, v18, v26 row_newbcast:15 row_mask:0xf bank_mask:0xf
    v_and_b32_dpp v35, v18, v27 row_newbcast:15 row_mask:0xf bank_mask:0xf
    v_mfma_f32_16x16x32_bf16 v[36:39], v[28:31], a[56:59], v[36:39]
    v_and_b32_dpp v28, v19, v24 row_newbcast:0 row_mask:0xf bank_mask:0xf
    v_and_b32_dpp v29, v19, v25 row_newbcast:0 row_mask:0xf bank_mask:0xf
    v_and_b32_dpp v30, v19, v26 row_newbcast:0 row_mask:0xf bank_mask:0xf
    v_and_b32_dpp v31, v19, v27 row_newbcast:0 row_mask:0xf bank_mask:0xf
    v_mfma_f32_16x16x32_bf16 v[36:39], v[32:35], a[60:63], v[36:39]
    v_and_b32_dpp v32, v19, v24 row_newbcast:1 row_mask:0xf bank_mask:0xf
    v_and_b32_dpp v33, v19, v25 row_newbcast:1 row_mask:0xf bank_mask:0xf
    v_and_b32_dpp v34, v19, v26 row_newbcast:1 row_mask:0xf bank_mask:0xf
    v_and_b32_dpp v35, v19, v27 row_newbcast:1 row_mask:0xf bank_mask:0xf
    v_mfma_f32_16x16x32_bf16 v[36:39], v[28:31], a[64:67], v[36:39]
    v_and_b32_dpp v28, v19, v24 row_newbcast:2 row_mask:0xf bank_mask:0xf
    v_and_b32_dpp v29, v19, v25 row_newbcast:2 row_mask:0xf bank_mask:0xf
    v_and_b32_dpp v30, v19, v26 row_newbcast:2 row_mask:0xf bank_mask:0xf
    v_and_b32_dpp v31, v19, v27 row_newbcast:2 row_mask:0xf bank_mask:0xf
    v_mfma_f32_16x16x32_bf16 v[36:39], v[32:35], a[68:71], v[36:39]
    v_and_b32_dpp v32, v19, v24 row_newbcast:3 row_mask:0xf bank_mask:0xf
    v_and_b32_dpp v33, v19, v25 row_newbcast:3 row_mask:0xf bank_mask:0xf
    v_and_b32_dpp v34, v19, v26 row_newbcast:3 row_mask:0xf bank_mask:0xf
    v_and_b32_dpp v35, v19, v27 row_newbcast:3 row_mask:0xf bank_mask:0xf
    v_mfma_f32_16x16x32_bf16 v[36:39], v[28:31], a[72:75], v[36:39]
    v_and_b32_dpp v28, v19, v24 row_newbcast:4 row_mask:0xf bank_mask:0xf
    v_and_b32_dpp v29, v19, v25 row_newbcast:4 row_mask:0xf bank_mask:0xf
    v_and_b32_dpp v30, v19, v26 row_newbcast:4 row_mask:0xf bank_mask:0xf
    v_and_b32_dpp v31, v19, v27 row_newbcast:4 row_mask:0xf bank_mask:0xf
    v_mfma_f32_16x16x32_bf16 v[36:39], v[32:35], a[76:79], v[36:39]
    v_and_b32_dpp v32, v19, v24 row_newbcast:5 row_mask:0xf bank_mask:0xf
    v_and_b32_dpp v33, v19, v25 row_newbcast:5 row_mask:0xf bank_mask:0xf
    v_and_b32_dpp v34, v19, v26 row_newbcast:5 row_mask:0xf bank_mask:0xf
    v_and_b32_dpp v35, v19, v27 row_newbcast:5 row_mask:0xf bank_mask:0xf
    v_mfma_f32_16x16x32_bf16 v[36:39], v[28:31], a[80:83], v[36:39]
    v_and_b32_dpp v28, v19, v24 row_newbcast:6 row_mask:0xf bank_mask:0xf
    v_and_b32_dpp v29, v19, v25 row_newbcast:6 row_mask:0xf bank_mask:0xf
    v_and_b32_dpp v30, v19, v26 row_newbcast:6 row_mask:0xf bank_mask:0xf
    v_and_b32_dpp v31, v19, v27 row_newbcast:6 row_mask:0xf bank_mask:0xf
    v_mfma_f32_16x16x32_bf16 v[36:39], v[32:35], a[84:87], v[36:39]
    v_and_b32_dpp v32, v19, v24 row_newbcast:7 row_mask:0xf bank_mask:0xf
    v_and_b32_dpp v33, v19, v25 row_newbcast:7 row_mask:0xf bank_mask:0xf
    v_and_b32_dpp v34, v19, v26 row_newbcast:7 row_mask:0xf bank_mask:0xf
    v_and_b32_dpp v35, v19, v27 row_newbcast:7 row_mask:0xf bank_mask:0xf
    v_mfma_f32_16x16x32_bf16 v[36:39], v[28:31], a[88:91], v[36:39]
    v_and_b32_dpp v28, v19, v24 row_newbcast:8 row_mask:0xf bank_mask:0xf
    v_and_b32_dpp v29, v19, v25 row_newbcast:8 row_mask:0xf bank_mask:0xf
    v_and_b32_dpp v30, v19, v26 row_newbcast:8 row_mask:0xf bank_mask:0xf
    v_and_b32_dpp v31, v19, v27 row_newbcast:8 row_mask:0xf bank_mask:0xf
    v_mfma_f32_16x16x32_bf16 v[36:39], v[32:35], a[92:95], v[36:39]
    v_and_b32_dpp v32, v19, v24 row_newbcast:9 row_mask:0xf bank_mask:0xf
    v_and_b32_dpp v33, v19, v25 row_newbcast:9 row_mask:0xf bank_mask:0xf
    v_and_b32_dpp v34, v19, v26 row_newbcast:9 row_mask:0xf bank_mask:0xf
    v_and_b32_dpp v35, v19, v27 row_newbcast:9 row_mask:0xf bank_mask:0xf
    v_mfma_f32_16x16x32_bf16 v[36:39], v[28:31], a[96:99], v[36:39]
    v_and_b32_dpp v28, v19, v24 row_newbcast:10 row_mask:0xf bank_mask:0xf
    v_and_b32_dpp v29, v19, v25 row_newbcast:10 row_mask:0xf bank_mask:0xf
    v_and_b32_dpp v30, v19, v26 row_newbcast:10 row_mask:0xf bank_mask:0xf
    v_and_b32_dpp v31, v19, v27 row_newbcast:10 row_mask:0xf bank_mask:0xf
    v_mfma_f32_16x16x32_bf16 v[36:39], v[32:35], a[100:103], v[36:39]
    v_and_b32_dpp v32, v19, v24 row_newbcast:11 row_mask:0xf bank_mask:0xf
    v_and_b32_dpp v33, v19, v25 row_newbcast:11 row_mask:0xf bank_mask:0xf
    v_and_b32_dpp v34, v19, v26 row_newbcast:11 row_mask:0xf bank_mask:0xf
    v_and_b32_dpp v35, v19, v27 row_newbcast:11 row_mask:0xf bank_mask:0xf
    v_mfma_f32_16x16x32_bf16 v[36:39], v[28:31], a[104:107], v[36:39]
    v_and_b32_dpp v28, v19, v24 row_newbcast:12 row_mask:0xf bank_mask:0xf
    v_and_b32_dpp v29, v19, v25 row_newbcast:12 row_mask:0xf bank_mask:0xf
    v_and_b32_dpp v30, v19, v26 row_newbcast:12 row_mask:0xf bank_mask:0xf
    v_and_b32_dpp v31, v19, v27 row_newbcast:12 row_mask:0xf bank_mask:0xf
    v_mfma_f32_16x16x32_bf16 v[36:39], v[32:35], a[108:111], v[36:39]
    v_and_b32_dpp v32, v19, v24 row_newbcast:13 row_mask:0xf bank_mask:0xf
    v_and_b32_dpp v33, v19, v25 row_newbcast:13 row_mask:0xf bank_mask:0xf
    v_and_b32_dpp v34, v19, v26 row_newbcast:13 row_mask:0xf bank_mask:0xf
    v_and_b32_dpp v35, v19, v27 row_newbcast:13 row_mask:0xf bank_mask:0xf
    v_mfma_f32_16x16x32_bf16 v[36:39], v[28:31], a[112:115], v[36:39]
    v_and_b32_dpp v28, v19, v24 row_newbcast:14 row_mask:0xf bank_mask:0xf
    v_and_b32_dpp v29, v19, v25 row_newbcast:14 row_mask:0xf bank_mask:0xf
    v_and_b32_dpp v30, v19, v26 row_newbcast:14 row_mask:0xf bank_mask:0xf
    v_and_b32_dpp v31, v19, v27 row_newbcast:14 row_mask:0xf bank_mask:0xf
    v_mfma_f32_16x16x32_bf16 v[36:39], v[32:35], a[116:119], v[36:39]
    v_and_b32_dpp v32, v19, v24 row_newbcast:15 row_mask:0xf bank_mask:0xf
    v_and_b32_dpp v33, v19, v25 row_newbcast:15 row_mask:0xf bank_mask:0xf
    v_and_b32_dpp v34, v19, v26 row_newbcast:15 row_mask:0xf bank_mask:0xf
    v_and_b32_dpp v35, v19, v27 row_newbcast:15 row_mask:0xf bank_mask:0xf
    v_mfma_f32_16x16x32_bf16 v[36:39], v[28:31], a[120:123], v[36:39]
    s_nop 0
    v_mfma_f32_16x16x32_bf16 v[36:39], v[32:35], a[124:127], v[36:39]
    s_mov_b32 exec_hi, 0
    s_mov_b32 s74, 0xff
    s_nop 5
    v_bfi_b32 v36, s74, v15, v36
    v_bfi_b32 v37, s74, v15, v37
    v_bfi_b32 v38, s74, v15, v38
    v_bfi_b32 v39, s74, v15, v39
    buffer_store_dwordx4 v[36:39], v8, s[28:31], 0 offen sc1
    s_cmp_lg_u32 s66, 0
    s_cbranch_scc1 L_end
    s_mov_b32 exec_hi, -1
    s_mov_b32 s88, 0
L_poll:
    buffer_load_dwordx4 v[56:59], v16, s[28:31], 0 offen offset:0 sc1
    buffer_load_dwordx4 v[60:63], v16, s[28:31], 0 offen offset:1024 sc1
    s_add_u32 s88, s88, 1
    s_waitcnt vmcnt(0)
    v_xor_b32 v56, s85, v56
    v_xor_b32 v57, s85, v57
    v_xor_b32 v58, s85, v58
    v_xor_b32 v59, s85, v59
    v_xor_b32 v60, s85, v60
    v_xor_b32 v61, s85, v61
    v_xor_b32 v62, s85, v62
    v_xor_b32 v63, s85, v63
    v_or3_b32 v28, v56, v57, v58
    v_or3_b32 v29, v59, v60, v61
    v_or3_b32 v28, v28, v62, v63
    v_or_b32 v28, v28, v29
    s_cmp_ge_u32 s88, 200000
    v_and_b32 v28, 0xff, v28
    s_cbranch_scc1 L_poll_ok
    v_cmp_ne_u32 vcc, 0, v28
    s_cbranch_vccnz L_poll
L_poll_ok:
    v_add_f32 v56, v56, v60
    v_add_f32 v57, v57, v61
    v_add_f32 v58, v58, v62
    v_add_f32 v59, v59, v63
    s_nop 0
    v_permlane32_swap_b32 v56, v58
    v_permlane32_swap_b32 v57, v59
    s_nop 0
    v_add_f32 v56, v56, v58
    v_add_f32 v57, v57, v59
    s_nop 1
    v_permlane16_swap_b32 v56, v57
    s_nop 0
    v_add_f32 v56, v56, v57
    s_nop 1
    v_add_f32_dpp v56, v56, v56 row_ror:8 row_mask:0xf bank_mask:0xf
    s_nop 1
    v_add_f32_dpp v56, v56, v56 row_ror:4 row_mask:0xf bank_mask:0xf
    s_mov_b32 exec_lo, 0x000f000f
    s_mov_b32 exec_hi, 0x000f000f
    v_cvt_pk_bf16_f32 v56, v56, v56
    buffer_store_short v56, v88, s[32:35], 0 offen
    s_cmp_lg_u32 s69, 0
    s_cbranch_scc1 L_end
    s_mov_b64 exec, 1
    buffer_store_dword v15, v13, s[28:31], s87 offen sc1
L_end:
    s_endpgm
.section .rodata,"a"
.p2align 6
.amdhsa_kernel concat_heads__mha_block_cached__mha_block_cached__decode_kernel
  .amdhsa_next_free_vgpr 412
  .amdhsa_next_free_sgpr 102
  .amdhsa_accum_offset 156
  .amdhsa_group_segment_fixed_size 0
  .amdhsa_kernarg_size 104
  .amdhsa_user_sgpr_count 2
  .amdhsa_user_sgpr_kernarg_segment_ptr 1
  .amdhsa_system_sgpr_workgroup_id_x 1
  .amdhsa_float_denorm_mode_32 3
.end_amdhsa_kernel
```
